```python
import torch

def _softmax(x, axis=-1):
    return torch.softmax(x, dim=axis)
def _gelu(x):
    return torch.nn.functional.gelu(x, approximate="tanh")
def _silu(x):
    return torch.nn.functional.silu(x)
def _sigmoid(x):
    return torch.sigmoid(x)
def _layernorm(x, axis=-1, eps=1e-5):
    m = x.mean(dim=axis, keepdim=True)
    v = x.var(dim=axis, keepdim=True, unbiased=False)
    return (x - m) / torch.sqrt(v + eps)
def _scatter_add(tgt, idx, src, axis=0):
    return tgt.clone().index_add_(axis, idx, src)
def _segment_sum(src, seg, n):
    out = torch.zeros((n,) + src.shape[1:], dtype=src.dtype)
    return out.index_add_(0, seg, src)
def _pad(x, pw):
    flat = tuple(v for pair in reversed(pw) for v in pair)
    return torch.nn.functional.pad(x, flat)

kernel_name = 'standalone__gqa_block_cached__sampling'

def setup_inputs():

    _w = (lambda a: (lambda t: t.to(torch.bfloat16) if t.is_floating_point() else t)(torch.as_tensor(a)))
    B, Sq, D = 32, 8, 512
    Hq, Hkv, Sk, Dh = 32, 8, 2048, 128
    assert Hq % Hkv == 0, (Hq, Hkv)
    return {
        "x": _w((lambda *s: torch.randn(*s, dtype=torch.bfloat16) * 0.8)(B, Sq, D)),
        "k_cache": _w((lambda *s: torch.randn(*s, dtype=torch.bfloat16) * 0.8)(B, Hkv, Sk, Dh)),
        "v_cache": _w((lambda *s: torch.randn(*s, dtype=torch.bfloat16) * 0.05)(B, Hkv, Sk, Dh)),
        "wq": _w((lambda *s: torch.randn(*s, dtype=torch.bfloat16) * 0.8)(D, Hq * Dh) * (D ** -0.5)),
        "wo": _w((lambda *s: torch.randn(*s, dtype=torch.bfloat16) * 0.05)(Hq * Dh, D) * ((Hq * Dh) ** -0.5)),
    }

def reference(x, k_cache, v_cache, wq, wo):
    B, Sq, D = x.shape
    Hq, Dh = 32, 128
    Hkv = k_cache.shape[1]
    rep = Hq // Hkv
    q = (lambda x, *d: x.permute(*d))((x @ wq).reshape(B, Sq, Hq, Dh), 0, 2, 1, 3)
    k = (lambda x, n, axis: torch.repeat_interleave(x, n, dim=axis))(k_cache, rep, axis=1)
    v = (lambda x, n, axis: torch.repeat_interleave(x, n, dim=axis))(v_cache, rep, axis=1)
    scores = torch.einsum("bhqd,bhkd->bhqk", q, k) * (Dh ** -0.5)
    p = _softmax(scores, axis=-1)
    o = torch.einsum("bhqk,bhkd->bhqd", p, v)
    return (lambda x, *d: x.permute(*d))(o, 0, 2, 1, 3).reshape(B, Sq, Hq * Dh) @ wo
```

```asm
; @launch grid=(256,1,1) block=(256,1,1) lds=163840
.amdgcn_target "amdgcn-amd-amdhsa--gfx950"
.text
.globl standalone__gqa_block_cached__sampling_kernel
.p2align 8
.type standalone__gqa_block_cached__sampling_kernel,@function
standalone__gqa_block_cached__sampling_kernel:
    s_cmp_ge_u32 s2, 256
    s_cbranch_scc1 L_end
    s_load_dwordx16 s[4:19], s[0:1], 0
    s_getpc_b64 s[96:97]
L_ipf:
    v_lshlrev_b32 v8, 7, v0
    v_min_u32 v8, L_end-L_ipf, v8
    global_load_dword v253, v8, s[96:97]
    v_lshrrev_b32 v1, 6, v0
    v_and_b32 v0, 63, v0
    s_nop 0
    v_readfirstlane_b32 s3, v1
    s_and_b32 s52, s2, 7
    s_lshr_b32 s53, s2, 3
    s_lshl_b32 s60, s52, 5
    s_add_u32 s60, s60, s53
    s_and_b32 s54, s52, 1
    s_lshl_b32 s61, s54, 3
    s_and_b32 s54, s53, 7
    s_add_u32 s61, s61, s54
    s_lshr_b32 s62, s52, 1
    s_lshl_b32 s62, s62, 2
    s_lshr_b32 s54, s53, 3
    s_add_u32 s62, s62, s54
    s_mul_i32 s48, s3, 40960
    v_lshrrev_b32 v2, 4, v0
    v_lshlrev_b32 v3, 2, v2
    v_and_b32 v4, 15, v0
    v_xor_b32 v3, v3, v4
    v_lshlrev_b32 v5, 8, v2
    v_mul_u32_u24 v7, 768, v2
    v_xor_b32 v6, 0, v3
    v_lshlrev_b32 v6, 4, v6
    v_add_u32 v200, v5, v6
    v_add_u32 v233, v7, v200
    v_xor_b32 v6, 1, v3
    v_lshlrev_b32 v6, 4, v6
    v_add_u32 v201, v5, v6
    v_add_u32 v234, v7, v201
    v_xor_b32 v6, 2, v3
    v_lshlrev_b32 v6, 4, v6
    v_add_u32 v202, v5, v6
    v_add_u32 v235, v7, v202
    v_xor_b32 v6, 3, v3
    v_lshlrev_b32 v6, 4, v6
    v_add_u32 v203, v5, v6
    v_add_u32 v236, v7, v203
    v_lshrrev_b32 v2, 3, v0
    v_bfe_u32 v3, v0, 4, 1
    v_lshlrev_b32 v3, 2, v3
    v_and_b32 v4, 7, v0
    v_xor_b32 v3, v3, v4
    v_lshlrev_b32 v3, 4, v3
    v_lshlrev_b32 v4, 13, v2
    v_add_u32 v237, v4, v3
    s_mul_i32 s49, s2, 0x9E3779B1
    s_lshr_b32 s49, s49, 26
    s_add_u32 s49, s49, s3
    s_lshl_b32 s49, s49, 13
    s_and_b32 s49, s49, 0x7ffff
    s_mov_b32 s50, s49
    s_lshl_b32 s63, s60, 19
    s_and_b32 s53, s2, 7
    s_lshl_b32 s53, s53, 3
    s_bfe_u32 s54, s2, 0x30003
    s_add_u32 s53, s53, s54
    s_lshl_b32 s53, s53, 7
    s_lshl_b32 s54, s3, 20
    s_add_u32 s82, s53, s54
    s_lshr_b32 s52, s2, 6
    s_lshl_b32 s84, s52, 2
    s_lshl_b32 s52, s52, 16
    s_lshl_b32 s54, s3, 8
    s_add_u32 s83, s52, s54
    s_bfe_u32 s85, s2, 0x30003
    s_lshl_b32 s85, s85, 1
    s_and_b32 s85, s85, 12
    s_waitcnt lgkmcnt(0)
    s_mov_b32 s32, s10
    s_mov_b32 s33, s11
    s_mov_b32 s34, 4194304
    s_mov_b32 s35, 0x20000
    s_mov_b32 s28, s4
    s_mov_b32 s29, s5
    s_mov_b32 s30, 262144
    s_mov_b32 s31, 0x20000
    s_add_u32 s20, s6, s63
    s_addc_u32 s21, s7, 0
    s_mov_b32 s22, 524288
    s_mov_b32 s23, 0x20000
    s_add_u32 s24, s8, s63
    s_addc_u32 s25, s9, 0
    s_mov_b32 s26, 524288
    s_mov_b32 s27, 0x20000
    s_mov_b32 s81, 131072
    s_load_dword s56, s[18:19], s81
    s_add_u32 s86, s49, 4096
    s_load_dword s98, s[20:21], s49
    s_load_dword s99, s[24:25], s49
    s_mov_b32 s36, s12
    s_mov_b32 s37, s13
    s_mov_b32 s38, 4194304
    s_mov_b32 s39, 0x20000
    s_mov_b32 s40, s18
    s_mov_b32 s41, s19
    s_mov_b32 s42, 6291456
    s_mov_b32 s43, 0x20000
    s_lshl_b32 s87, s2, 4
    s_lshl_b32 s53, s3, 2
    s_add_u32 s87, s87, s53
    s_lshl_b32 s52, s87, 10
    s_add_u32 s52, s52, 384
    v_bfe_u32 v2, v0, 3, 2
    v_lshlrev_b32 v2, 10, v2
    v_and_b32 v3, 7, v0
    v_lshlrev_b32 v3, 4, v3
    v_add_u32 v2, v2, v3
    s_mov_b32 exec_hi, 0
    buffer_load_dwordx4 v[112:115], v2, s[36:39], s52 offen
    s_mov_b64 exec, -1
    s_lshl_b32 s52, s84, 10
    s_add_u32 s52, s52, 24576
    s_add_u32 m0, s48, s52
    s_lshl_b32 s53, s84, 16
    s_add_u32 s53, s53, s82
    buffer_load_dwordx4 v237, s[32:35], s53 offen lds
    s_add_u32 s84, s84, 1
    s_and_b32 s84, s84, 15
    s_lshl_b32 s52, s85, 10
    s_add_u32 m0, s48, s52
    s_lshl_b32 s53, s85, 12
    s_add_u32 s53, s53, s83
    buffer_load_dwordx4 v233, s[28:31], s53 offen lds
    s_add_u32 s85, s85, 1
    s_and_b32 s85, s85, 15
    s_lshl_b32 s52, s84, 10
    s_add_u32 s52, s52, 24576
    s_add_u32 m0, s48, s52
    s_lshl_b32 s53, s84, 16
    s_add_u32 s53, s53, s82
    buffer_load_dwordx4 v237, s[32:35], s53 offen lds
    s_add_u32 s84, s84, 1
    s_and_b32 s84, s84, 15
    s_lshl_b32 s52, s85, 10
    s_add_u32 m0, s48, s52
    s_lshl_b32 s53, s85, 12
    s_add_u32 s53, s53, s83
    buffer_load_dwordx4 v234, s[28:31], s53 offen lds
    s_add_u32 s85, s85, 1
    s_and_b32 s85, s85, 15
    s_lshl_b32 s52, s84, 10
    s_add_u32 s52, s52, 24576
    s_add_u32 m0, s48, s52
    s_lshl_b32 s53, s84, 16
    s_add_u32 s53, s53, s82
    buffer_load_dwordx4 v237, s[32:35], s53 offen lds
    s_add_u32 s84, s84, 1
    s_and_b32 s84, s84, 15
    s_lshl_b32 s52, s85, 10
    s_add_u32 m0, s48, s52
    s_lshl_b32 s53, s85, 12
    s_add_u32 s53, s53, s83
    buffer_load_dwordx4 v235, s[28:31], s53 offen lds
    s_add_u32 s85, s85, 1
    s_and_b32 s85, s85, 15
    s_lshl_b32 s52, s84, 10
    s_add_u32 s52, s52, 24576
    s_add_u32 m0, s48, s52
    s_lshl_b32 s53, s84, 16
    s_add_u32 s53, s53, s82
    buffer_load_dwordx4 v237, s[32:35], s53 offen lds
    s_add_u32 s84, s84, 1
    s_and_b32 s84, s84, 15
    s_lshl_b32 s52, s85, 10
    s_add_u32 m0, s48, s52
    s_lshl_b32 s53, s85, 12
    s_add_u32 s53, s53, s83
    buffer_load_dwordx4 v236, s[28:31], s53 offen lds
    s_add_u32 s85, s85, 1
    s_and_b32 s85, s85, 15
    s_lshl_b32 s52, s84, 10
    s_add_u32 s52, s52, 24576
    s_add_u32 m0, s48, s52
    s_lshl_b32 s53, s84, 16
    s_add_u32 s53, s53, s82
    buffer_load_dwordx4 v237, s[32:35], s53 offen lds
    s_add_u32 s84, s84, 1
    s_and_b32 s84, s84, 15
    s_lshl_b32 s52, s85, 10
    s_add_u32 m0, s48, s52
    s_lshl_b32 s53, s85, 12
    s_add_u32 s53, s53, s83
    buffer_load_dwordx4 v233, s[28:31], s53 offen lds
    s_add_u32 s85, s85, 1
    s_and_b32 s85, s85, 15
    s_lshl_b32 s52, s84, 10
    s_add_u32 s52, s52, 24576
    s_add_u32 m0, s48, s52
    s_lshl_b32 s53, s84, 16
    s_add_u32 s53, s53, s82
    buffer_load_dwordx4 v237, s[32:35], s53 offen lds
    s_add_u32 s84, s84, 1
    s_and_b32 s84, s84, 15
    s_lshl_b32 s52, s85, 10
    s_add_u32 m0, s48, s52
    s_lshl_b32 s53, s85, 12
    s_add_u32 s53, s53, s83
    buffer_load_dwordx4 v234, s[28:31], s53 offen lds
    s_add_u32 s85, s85, 1
    s_and_b32 s85, s85, 15
    s_lshl_b32 s52, s84, 10
    s_add_u32 s52, s52, 24576
    s_add_u32 m0, s48, s52
    s_lshl_b32 s53, s84, 16
    s_add_u32 s53, s53, s82
    buffer_load_dwordx4 v237, s[32:35], s53 offen lds
    s_add_u32 s84, s84, 1
    s_and_b32 s84, s84, 15
    s_lshl_b32 s52, s85, 10
    s_add_u32 m0, s48, s52
    s_lshl_b32 s53, s85, 12
    s_add_u32 s53, s53, s83
    buffer_load_dwordx4 v235, s[28:31], s53 offen lds
    s_add_u32 s85, s85, 1
    s_and_b32 s85, s85, 15
    s_lshl_b32 s52, s84, 10
    s_add_u32 s52, s52, 24576
    s_add_u32 m0, s48, s52
    s_lshl_b32 s53, s84, 16
    s_add_u32 s53, s53, s82
    buffer_load_dwordx4 v237, s[32:35], s53 offen lds
    s_add_u32 s84, s84, 1
    s_and_b32 s84, s84, 15
    s_lshl_b32 s52, s85, 10
    s_add_u32 m0, s48, s52
    s_lshl_b32 s53, s85, 12
    s_add_u32 s53, s53, s83
    buffer_load_dwordx4 v236, s[28:31], s53 offen lds
    s_add_u32 s85, s85, 1
    s_and_b32 s85, s85, 15
    s_lshl_b32 s52, s84, 10
    s_add_u32 s52, s52, 24576
    s_add_u32 m0, s48, s52
    s_lshl_b32 s53, s84, 16
    s_add_u32 s53, s53, s82
    buffer_load_dwordx4 v237, s[32:35], s53 offen lds
    s_add_u32 s84, s84, 1
    s_and_b32 s84, s84, 15
    s_lshl_b32 s52, s85, 10
    s_add_u32 m0, s48, s52
    s_lshl_b32 s53, s85, 12
    s_add_u32 s53, s53, s83
    buffer_load_dwordx4 v233, s[28:31], s53 offen lds
    s_add_u32 s85, s85, 1
    s_and_b32 s85, s85, 15
    s_lshl_b32 s52, s84, 10
    s_add_u32 s52, s52, 24576
    s_add_u32 m0, s48, s52
    s_lshl_b32 s53, s84, 16
    s_add_u32 s53, s53, s82
    buffer_load_dwordx4 v237, s[32:35], s53 offen lds
    s_add_u32 s84, s84, 1
    s_and_b32 s84, s84, 15
    s_lshl_b32 s52, s85, 10
    s_add_u32 m0, s48, s52
    s_lshl_b32 s53, s85, 12
    s_add_u32 s53, s53, s83
    buffer_load_dwordx4 v234, s[28:31], s53 offen lds
    s_add_u32 s85, s85, 1
    s_and_b32 s85, s85, 15
    s_lshl_b32 s52, s84, 10
    s_add_u32 s52, s52, 24576
    s_add_u32 m0, s48, s52
    s_lshl_b32 s53, s84, 16
    s_add_u32 s53, s53, s82
    buffer_load_dwordx4 v237, s[32:35], s53 offen lds
    s_add_u32 s84, s84, 1
    s_and_b32 s84, s84, 15
    s_lshl_b32 s52, s85, 10
    s_add_u32 m0, s48, s52
    s_lshl_b32 s53, s85, 12
    s_add_u32 s53, s53, s83
    buffer_load_dwordx4 v235, s[28:31], s53 offen lds
    s_add_u32 s85, s85, 1
    s_and_b32 s85, s85, 15
    s_lshl_b32 s52, s84, 10
    s_add_u32 s52, s52, 24576
    s_add_u32 m0, s48, s52
    s_lshl_b32 s53, s84, 16
    s_add_u32 s53, s53, s82
    buffer_load_dwordx4 v237, s[32:35], s53 offen lds
    s_add_u32 s84, s84, 1
    s_and_b32 s84, s84, 15
    s_lshl_b32 s52, s85, 10
    s_add_u32 m0, s48, s52
    s_lshl_b32 s53, s85, 12
    s_add_u32 s53, s53, s83
    buffer_load_dwordx4 v236, s[28:31], s53 offen lds
    s_add_u32 s85, s85, 1
    s_and_b32 s85, s85, 15
    s_lshl_b32 s52, s84, 10
    s_add_u32 s52, s52, 24576
    s_add_u32 m0, s48, s52
    s_lshl_b32 s53, s84, 16
    s_add_u32 s53, s53, s82
    buffer_load_dwordx4 v237, s[32:35], s53 offen lds
    s_add_u32 s84, s84, 1
    s_and_b32 s84, s84, 15
    s_lshl_b32 s52, s85, 10
    s_add_u32 m0, s48, s52
    s_lshl_b32 s53, s85, 12
    s_add_u32 s53, s53, s83
    buffer_load_dwordx4 v233, s[28:31], s53 offen lds
    s_add_u32 s85, s85, 1
    s_and_b32 s85, s85, 15
    s_lshl_b32 s52, s84, 10
    s_add_u32 s52, s52, 24576
    s_add_u32 m0, s48, s52
    s_lshl_b32 s53, s84, 16
    s_add_u32 s53, s53, s82
    buffer_load_dwordx4 v237, s[32:35], s53 offen lds
    s_add_u32 s84, s84, 1
    s_and_b32 s84, s84, 15
    s_lshl_b32 s52, s85, 10
    s_add_u32 m0, s48, s52
    s_lshl_b32 s53, s85, 12
    s_add_u32 s53, s53, s83
    buffer_load_dwordx4 v234, s[28:31], s53 offen lds
    s_add_u32 s85, s85, 1
    s_and_b32 s85, s85, 15
    s_lshl_b32 s52, s84, 10
    s_add_u32 s52, s52, 24576
    s_add_u32 m0, s48, s52
    s_lshl_b32 s53, s84, 16
    s_add_u32 s53, s53, s82
    buffer_load_dwordx4 v237, s[32:35], s53 offen lds
    s_add_u32 s84, s84, 1
    s_and_b32 s84, s84, 15
    s_lshl_b32 s52, s85, 10
    s_add_u32 m0, s48, s52
    s_lshl_b32 s53, s85, 12
    s_add_u32 s53, s53, s83
    buffer_load_dwordx4 v235, s[28:31], s53 offen lds
    s_add_u32 s85, s85, 1
    s_and_b32 s85, s85, 15
    s_lshl_b32 s52, s84, 10
    s_add_u32 s52, s52, 24576
    s_add_u32 m0, s48, s52
    s_lshl_b32 s53, s84, 16
    s_add_u32 s53, s53, s82
    buffer_load_dwordx4 v237, s[32:35], s53 offen lds
    s_add_u32 s84, s84, 1
    s_and_b32 s84, s84, 15
    s_lshl_b32 s52, s85, 10
    s_add_u32 m0, s48, s52
    s_lshl_b32 s53, s85, 12
    s_add_u32 s53, s53, s83
    buffer_load_dwordx4 v236, s[28:31], s53 offen lds
    s_add_u32 s85, s85, 1
    s_and_b32 s85, s85, 15
    s_add_u32 m0, s48, 16384
    s_nop 0
    buffer_load_dwordx4 v200, s[20:23], s49 offen offset:0 nt lds
    buffer_load_dwordx4 v201, s[20:23], s49 offen offset:1024 nt lds
    buffer_load_dwordx4 v202, s[20:23], s49 offen offset:2048 nt lds
    buffer_load_dwordx4 v203, s[20:23], s49 offen offset:3072 nt lds
    s_add_u32 m0, s48, 20480
    s_add_u32 s63, s49, 4096
    buffer_load_dwordx4 v200, s[20:23], s63 offen offset:0 nt lds
    buffer_load_dwordx4 v201, s[20:23], s63 offen offset:1024 nt lds
    buffer_load_dwordx4 v202, s[20:23], s63 offen offset:2048 nt lds
    buffer_load_dwordx4 v203, s[20:23], s63 offen offset:3072 nt lds
    s_add_u32 s49, s49, 32768
    s_and_b32 s49, s49, 0x7ffff
    v_lshlrev_b32 v240, 4, v0
    v_and_b32 v2, 31, v0
    v_lshrrev_b32 v3, 5, v0
    v_and_b32 v4, 3, v2
    v_lshlrev_b32 v4, 2, v4
    v_bfe_u32 v5, v2, 2, 2
    v_or_b32 v4, v4, v5
    v_xor_b32 v4, v4, v3
    v_lshlrev_b32 v4, 4, v4
    v_lshlrev_b32 v5, 8, v2
    v_add_u32 v4, v4, v5
    v_xor_b32 v5, 0, v4
    v_add_u32 v204, s48, v5
    v_xor_b32 v5, 32, v4
    v_add_u32 v205, s48, v5
    v_xor_b32 v5, 64, v4
    v_add_u32 v206, s48, v5
    v_xor_b32 v5, 96, v4
    v_add_u32 v207, s48, v5
    v_xor_b32 v5, 128, v4
    v_add_u32 v208, s48, v5
    v_xor_b32 v5, 160, v4
    v_add_u32 v209, s48, v5
    v_xor_b32 v5, 192, v4
    v_add_u32 v210, s48, v5
    v_xor_b32 v5, 224, v4
    v_add_u32 v211, s48, v5
    v_bfe_u32 v4, v0, 2, 2
    v_lshlrev_b32 v5, 2, v3
    v_add_u32 v5, v5, v4
    v_lshlrev_b32 v5, 8, v5
    v_lshlrev_b32 v6, 6, v4
    v_add_u32 v5, v5, v6
    v_bfe_u32 v6, v0, 4, 1
    v_lshlrev_b32 v6, 1, v6
    v_bfe_u32 v8, v0, 1, 1
    v_or_b32 v6, v6, v8
    v_xor_b32 v6, v6, v3
    v_lshlrev_b32 v6, 4, v6
    v_add_u32 v5, v5, v6
    v_and_b32 v6, 1, v0
    v_lshlrev_b32 v6, 3, v6
    v_add_u32 v5, v5, v6
    v_xor_b32 v6, 0, v5
    v_add_u32 v212, s48, v6
    v_xor_b32 v6, 32, v5
    v_add_u32 v213, s48, v6
    v_xor_b32 v6, 64, v5
    v_add_u32 v214, s48, v6
    v_xor_b32 v6, 96, v5
    v_add_u32 v215, s48, v6
    v_xor_b32 v6, 128, v5
    v_add_u32 v216, s48, v6
    v_xor_b32 v6, 160, v5
    v_add_u32 v217, s48, v6
    v_xor_b32 v6, 192, v5
    v_add_u32 v218, s48, v6
    v_xor_b32 v6, 224, v5
    v_add_u32 v219, s48, v6
    v_lshlrev_b32 v5, 10, v3
    v_lshlrev_b32 v6, 7, v4
    v_add_u32 v5, v5, v6
    v_lshrrev_b32 v6, 1, v4
    v_lshlrev_b32 v6, 6, v6
    v_add_u32 v5, v5, v6
    v_and_b32 v6, 3, v0
    v_lshlrev_b32 v6, 3, v6
    v_add_u32 v7, v5, v6
    v_bfe_u32 v6, v0, 4, 1
    v_lshlrev_b32 v6, 5, v6
    v_add_u32 v5, v7, v6
    v_add_u32 v238, s48, v5
    v_xor_b32 v239, 64, v238
    v_lshrrev_b32 v2, 4, v0
    v_lshlrev_b32 v5, 9, v2
    v_bfe_u32 v6, v0, 2, 2
    v_lshlrev_b32 v6, 6, v6
    v_add_u32 v5, v5, v6
    v_bfe_u32 v6, v0, 1, 1
    v_and_b32 v7, 1, v2
    v_lshlrev_b32 v7, 1, v7
    v_xor_b32 v6, v6, v7
    v_lshlrev_b32 v6, 4, v6
    v_add_u32 v5, v5, v6
    v_and_b32 v6, 1, v0
    v_lshlrev_b32 v6, 3, v6
    v_add_u32 v5, v5, v6
    v_add_u32 v242, s48, v5
    v_xor_b32 v243, 32, v242
    s_waitcnt vmcnt(8)
    ds_read_b128 a[128:131], v204 offset:0
    ds_read_b128 a[132:135], v205 offset:0
    ds_read_b128 a[136:139], v206 offset:0
    ds_read_b128 a[140:143], v207 offset:0
    ds_read_b128 a[144:147], v208 offset:0
    ds_read_b128 a[148:151], v209 offset:0
    ds_read_b128 a[152:155], v210 offset:0
    ds_read_b128 a[156:159], v211 offset:0
    ds_read_b128 a[160:163], v204 offset:8192
    ds_read_b128 a[164:167], v205 offset:8192
    ds_read_b128 a[168:171], v206 offset:8192
    ds_read_b128 a[172:175], v207 offset:8192
    ds_read_b128 a[176:179], v208 offset:8192
    ds_read_b128 a[180:183], v209 offset:8192
    ds_read_b128 a[184:187], v210 offset:8192
    ds_read_b128 a[188:191], v211 offset:8192
    ds_read_b64_tr_b16 a[64:65], v238 offset:24576
    ds_read_b64_tr_b16 a[66:67], v238 offset:25088
    ds_read_b64_tr_b16 a[68:69], v238 offset:26624
    ds_read_b64_tr_b16 a[70:71], v238 offset:27136
    ds_read_b64_tr_b16 a[72:73], v238 offset:28672
    ds_read_b64_tr_b16 a[74:75], v238 offset:29184
    ds_read_b64_tr_b16 a[76:77], v238 offset:30720
    ds_read_b64_tr_b16 a[78:79], v238 offset:31232
    ds_read_b64_tr_b16 a[80:81], v238 offset:32768
    ds_read_b64_tr_b16 a[82:83], v238 offset:33280
    ds_read_b64_tr_b16 a[84:85], v238 offset:34816
    ds_read_b64_tr_b16 a[86:87], v238 offset:35328
    ds_read_b64_tr_b16 a[88:89], v238 offset:36864
    ds_read_b64_tr_b16 a[90:91], v238 offset:37376
    ds_read_b64_tr_b16 a[92:93], v238 offset:38912
    ds_read_b64_tr_b16 a[94:95], v238 offset:39424
    ds_read_b64_tr_b16 a[96:97], v239 offset:24576
    ds_read_b64_tr_b16 a[98:99], v239 offset:25088
    ds_read_b64_tr_b16 a[100:101], v239 offset:26624
    ds_read_b64_tr_b16 a[102:103], v239 offset:27136
    ds_read_b64_tr_b16 a[104:105], v239 offset:28672
    ds_read_b64_tr_b16 a[106:107], v239 offset:29184
    ds_read_b64_tr_b16 a[108:109], v239 offset:30720
    ds_read_b64_tr_b16 a[110:111], v239 offset:31232
    ds_read_b64_tr_b16 a[112:113], v239 offset:32768
    ds_read_b64_tr_b16 a[114:115], v239 offset:33280
    ds_read_b64_tr_b16 a[116:117], v239 offset:34816
    ds_read_b64_tr_b16 a[118:119], v239 offset:35328
    ds_read_b64_tr_b16 a[120:121], v239 offset:36864
    ds_read_b64_tr_b16 a[122:123], v239 offset:37376
    ds_read_b64_tr_b16 a[124:125], v239 offset:38912
    ds_read_b64_tr_b16 a[126:127], v239 offset:39424
    s_lshl_b32 s87, s87, 7
    s_add_u32 s87, s87, 196608
    v_and_b32 v2, 31, v0
    v_lshlrev_b32 v2, 4, v2
    s_mov_b32 exec_hi, 0
    buffer_store_dwordx4 v[112:115], v2, s[40:43], s87 offen sc1
    s_mov_b64 exec, -1
    s_waitcnt lgkmcnt(0)
    s_add_u32 m0, s48, 0
    s_nop 0
    buffer_load_dwordx4 v200, s[24:27], s50 offen offset:0 nt lds
    buffer_load_dwordx4 v201, s[24:27], s50 offen offset:1024 nt lds
    buffer_load_dwordx4 v202, s[24:27], s50 offen offset:2048 nt lds
    buffer_load_dwordx4 v203, s[24:27], s50 offen offset:3072 nt lds
    s_add_u32 m0, s48, 4096
    s_add_u32 s63, s50, 4096
    buffer_load_dwordx4 v200, s[24:27], s63 offen offset:0 nt lds
    buffer_load_dwordx4 v201, s[24:27], s63 offen offset:1024 nt lds
    buffer_load_dwordx4 v202, s[24:27], s63 offen offset:2048 nt lds
    buffer_load_dwordx4 v203, s[24:27], s63 offen offset:3072 nt lds
    s_add_u32 s50, s50, 32768
    s_and_b32 s50, s50, 0x7ffff
    v_mfma_f32_32x32x16_bf16 a[0:15], a[64:67], a[128:131], 0
    v_mfma_f32_32x32x16_bf16 a[16:31], a[96:99], a[128:131], 0
    v_mfma_f32_32x32x16_bf16 a[32:47], a[64:67], a[160:163], 0
    v_mfma_f32_32x32x16_bf16 a[48:63], a[96:99], a[160:163], 0
    v_mfma_f32_32x32x16_bf16 a[0:15], a[68:71], a[132:135], a[0:15]
    v_mfma_f32_32x32x16_bf16 a[16:31], a[100:103], a[132:135], a[16:31]
    v_mfma_f32_32x32x16_bf16 a[32:47], a[68:71], a[164:167], a[32:47]
    v_mfma_f32_32x32x16_bf16 a[48:63], a[100:103], a[164:167], a[48:63]
    v_mfma_f32_32x32x16_bf16 a[0:15], a[72:75], a[136:139], a[0:15]
    v_mfma_f32_32x32x16_bf16 a[16:31], a[104:107], a[136:139], a[16:31]
    v_mfma_f32_32x32x16_bf16 a[32:47], a[72:75], a[168:171], a[32:47]
    v_mfma_f32_32x32x16_bf16 a[48:63], a[104:107], a[168:171], a[48:63]
    v_mfma_f32_32x32x16_bf16 a[0:15], a[76:79], a[140:143], a[0:15]
    v_mfma_f32_32x32x16_bf16 a[16:31], a[108:111], a[140:143], a[16:31]
    v_mfma_f32_32x32x16_bf16 a[32:47], a[76:79], a[172:175], a[32:47]
    v_mfma_f32_32x32x16_bf16 a[48:63], a[108:111], a[172:175], a[48:63]
    v_mfma_f32_32x32x16_bf16 a[0:15], a[80:83], a[144:147], a[0:15]
    v_mfma_f32_32x32x16_bf16 a[16:31], a[112:115], a[144:147], a[16:31]
    v_mfma_f32_32x32x16_bf16 a[32:47], a[80:83], a[176:179], a[32:47]
    v_mfma_f32_32x32x16_bf16 a[48:63], a[112:115], a[176:179], a[48:63]
    v_mfma_f32_32x32x16_bf16 a[0:15], a[84:87], a[148:151], a[0:15]
    v_mfma_f32_32x32x16_bf16 a[16:31], a[116:119], a[148:151], a[16:31]
    v_mfma_f32_32x32x16_bf16 a[32:47], a[84:87], a[180:183], a[32:47]
    v_mfma_f32_32x32x16_bf16 a[48:63], a[116:119], a[180:183], a[48:63]
    v_mfma_f32_32x32x16_bf16 a[0:15], a[88:91], a[152:155], a[0:15]
    v_mfma_f32_32x32x16_bf16 a[16:31], a[120:123], a[152:155], a[16:31]
    v_mfma_f32_32x32x16_bf16 a[32:47], a[88:91], a[184:187], a[32:47]
    v_mfma_f32_32x32x16_bf16 a[48:63], a[120:123], a[184:187], a[48:63]
    v_mfma_f32_32x32x16_bf16 a[0:15], a[92:95], a[156:159], a[0:15]
    v_mfma_f32_32x32x16_bf16 a[16:31], a[124:127], a[156:159], a[16:31]
    v_mfma_f32_32x32x16_bf16 a[32:47], a[92:95], a[188:191], a[32:47]
    v_mfma_f32_32x32x16_bf16 a[48:63], a[124:127], a[188:191], a[48:63]
    v_add_u32 v9, s48, v240
    s_nop 7
    ds_write_b128 v9, a[0:3] offset:24576
    ds_write_b128 v9, a[4:7] offset:25600
    ds_write_b128 v9, a[8:11] offset:26624
    ds_write_b128 v9, a[12:15] offset:27648
    ds_write_b128 v9, a[16:19] offset:28672
    ds_write_b128 v9, a[20:23] offset:29696
    ds_write_b128 v9, a[24:27] offset:30720
    ds_write_b128 v9, a[28:31] offset:31744
    ds_write_b128 v9, a[32:35] offset:32768
    ds_write_b128 v9, a[36:39] offset:33792
    ds_write_b128 v9, a[40:43] offset:34816
    ds_write_b128 v9, a[44:47] offset:35840
    ds_write_b128 v9, a[48:51] offset:36864
    ds_write_b128 v9, a[52:55] offset:37888
    ds_write_b128 v9, a[56:59] offset:38912
    ds_write_b128 v9, a[60:63] offset:39936
    s_lshl_b32 s52, s3, 12
    s_add_u32 s52, s52, 24576
    v_add_u32 v9, s52, v240
    v_add_u32 v10, 81920, v9
    s_waitcnt lgkmcnt(0)
    s_barrier
    ds_read_b128 v[48:51], v9 offset:0
    ds_read_b128 v[52:55], v9 offset:1024
    ds_read_b128 v[56:59], v9 offset:2048
    ds_read_b128 v[60:63], v9 offset:3072
    ds_read_b128 v[64:67], v9 offset:40960
    ds_read_b128 v[68:71], v9 offset:41984
    ds_read_b128 v[72:75], v9 offset:43008
    ds_read_b128 v[76:79], v9 offset:44032
    ds_read_b128 v[80:83], v10 offset:0
    ds_read_b128 v[84:87], v10 offset:1024
    ds_read_b128 v[88:91], v10 offset:2048
    ds_read_b128 v[92:95], v10 offset:3072
    ds_read_b128 v[96:99], v10 offset:40960
    ds_read_b128 v[100:103], v10 offset:41984
    ds_read_b128 v[104:107], v10 offset:43008
    ds_read_b128 v[108:111], v10 offset:44032
    s_and_b32 s52, s3, 1
    s_lshr_b32 s53, s3, 1
    s_lshr_b32 s54, s2, 6
    s_lshl_b32 s54, s54, 3
    s_lshl_b32 s53, s53, 2
    s_add_u32 s54, s54, s53
    s_lshl_b32 s54, s54, 3
    s_and_b32 s53, s2, 7
    s_add_u32 s54, s54, s53
    s_lshl_b32 s54, s54, 13
    s_bfe_u32 s53, s2, 0x10003
    s_lshl_b32 s53, s53, 2
    s_lshl_b32 s52, s52, 1
    s_add_u32 s53, s53, s52
    s_lshl_b32 s53, s53, 10
    s_add_u32 s54, s54, s53
    s_bfe_u32 s53, s2, 0x20004
    s_lshl_b32 s53, s53, 7
    s_add_u32 s54, s54, s53
    s_add_u32 s54, s54, 786432
    v_bfe_u32 v12, v0, 3, 2
    v_lshlrev_b32 v12, 16, v12
    v_and_b32 v13, 7, v0
    v_lshlrev_b32 v13, 4, v13
    v_add_u32 v12, v12, v13
    v_lshrrev_b32 v13, 5, v0
    v_lshlrev_b32 v13, 9, v13
    v_add_u32 v12, v12, v13
    s_waitcnt lgkmcnt(0)
    v_add_f32 v48, v48, v64
    v_add_f32 v80, v80, v96
    v_add_f32 v49, v49, v65
    v_add_f32 v81, v81, v97
    v_add_f32 v50, v50, v66
    v_add_f32 v82, v82, v98
    v_add_f32 v51, v51, v67
    v_add_f32 v83, v83, v99
    v_add_f32 v52, v52, v68
    v_add_f32 v84, v84, v100
    v_add_f32 v53, v53, v69
    v_add_f32 v85, v85, v101
    v_add_f32 v54, v54, v70
    v_add_f32 v86, v86, v102
    v_add_f32 v55, v55, v71
    v_add_f32 v87, v87, v103
    v_add_f32 v56, v56, v72
    v_add_f32 v88, v88, v104
    v_add_f32 v57, v57, v73
    v_add_f32 v89, v89, v105
    v_add_f32 v58, v58, v74
    v_add_f32 v90, v90, v106
    v_add_f32 v59, v59, v75
    v_add_f32 v91, v91, v107
    v_add_f32 v60, v60, v76
    v_add_f32 v92, v92, v108
    v_add_f32 v61, v61, v77
    v_add_f32 v93, v93, v109
    v_add_f32 v62, v62, v78
    v_add_f32 v94, v94, v110
    v_add_f32 v63, v63, v79
    v_add_f32 v95, v95, v111
    v_add_f32 v48, v48, v80
    v_add_f32 v49, v49, v81
    v_add_f32 v50, v50, v82
    v_add_f32 v51, v51, v83
    v_add_f32 v52, v52, v84
    v_add_f32 v53, v53, v85
    v_add_f32 v54, v54, v86
    v_add_f32 v55, v55, v87
    v_add_f32 v56, v56, v88
    v_add_f32 v57, v57, v89
    v_add_f32 v58, v58, v90
    v_add_f32 v59, v59, v91
    v_add_f32 v60, v60, v92
    v_add_f32 v61, v61, v93
    v_add_f32 v62, v62, v94
    v_add_f32 v63, v63, v95
    v_cvt_pk_bf16_f32 v192, v48, v49
    v_cvt_pk_bf16_f32 v193, v50, v51
    v_cvt_pk_bf16_f32 v194, v52, v53
    v_cvt_pk_bf16_f32 v195, v54, v55
    v_cvt_pk_bf16_f32 v196, v56, v57
    v_cvt_pk_bf16_f32 v197, v58, v59
    v_cvt_pk_bf16_f32 v198, v60, v61
    v_cvt_pk_bf16_f32 v199, v62, v63
    s_nop 1
    v_permlane32_swap_b32 v192, v194
    v_permlane32_swap_b32 v193, v195
    v_permlane32_swap_b32 v196, v198
    v_permlane32_swap_b32 v197, v199
    buffer_store_dwordx4 v[192:195], v12, s[40:43], s54 offen sc1
    buffer_store_dwordx4 v[196:199], v12, s[40:43], s54 offen offset:1024 sc1
    s_mul_i32 s56, s56, 0x9E3779B1
    s_add_u32 s56, s56, 0x7F4A7C15
    s_and_b32 s52, s60, 7
    s_lshr_b32 s53, s60, 6
    s_lshl_b32 s53, s53, 6
    s_add_u32 s52, s52, s53
    s_lshl_b32 s52, s52, 7
    s_add_u32 s52, s52, 0
    v_and_b32 v2, 7, v0
    v_lshlrev_b32 v2, 10, v2
    v_add_u32 v221, s52, v2
    s_lshl_b32 s80, s60, 13
    s_add_u32 s80, s80, 786432
    s_lshl_b32 s52, s3, 6
    s_lshl_b32 s52, s52, 7
    s_add_u32 s52, s52, 0
    v_lshlrev_b32 v2, 7, v0
    v_add_u32 v223, s52, v2
    s_mov_b32 s57, 0
    s_mov_b32 s55, 0x3e0293ee
    s_lshr_b32 s52, s62, 1
    s_cmp_eq_u32 s52, 3
    s_cselect_b32 s95, 1, 0
    s_cselect_b32 s88, 7, 10
    s_cselect_b32 s53, 196608, 0
    s_add_u32 s54, s18, s53
    s_addc_u32 s63, s19, 0
    s_cmp_eq_u32 s52, 3
    s_cselect_b32 s36, s54, s12
    s_cselect_b32 s37, s63, s13
    s_mov_b32 s38, 4194304
    s_cselect_b32 s38, 524288, s38
    s_mov_b32 s39, 0x20000
    s_cselect_b32 s53, 1, 15
    s_and_b32 s53, s62, s53
    s_lshl_b32 s53, s53, 6
    s_lshl_b32 s51, s3, 10
    s_lshl_b32 s51, s51, s88
    s_add_u32 s51, s51, s53
    s_add_u32 s52, s88, 4
    s_lshl_b32 s94, 1, s52
    v_lshrrev_b32 v2, 2, v0
    v_lshlrev_b32 v2, s88, v2
    v_bfe_u32 v5, v0, 5, 1
    v_lshlrev_b32 v5, 1, v5
    v_and_b32 v6, 3, v0
    v_xor_b32 v5, v5, v6
    v_lshlrev_b32 v5, 4, v5
    v_add_u32 v241, v2, v5
    s_waitcnt vmcnt(11)
    ds_read_b128 v[128:131], v204 offset:16384
    ds_read_b128 v[132:135], v205 offset:16384
    ds_read_b128 v[136:139], v206 offset:16384
    ds_read_b128 v[140:143], v207 offset:16384
    ds_read_b128 v[144:147], v208 offset:16384
    ds_read_b128 v[148:151], v209 offset:16384
    ds_read_b128 v[152:155], v210 offset:16384
    ds_read_b128 v[156:159], v211 offset:16384
    s_waitcnt lgkmcnt(0)
    s_add_u32 m0, s48, 8192
    s_nop 0
    buffer_load_dwordx4 v200, s[20:23], s49 offen offset:0 nt lds
    buffer_load_dwordx4 v201, s[20:23], s49 offen offset:1024 nt lds
    buffer_load_dwordx4 v202, s[20:23], s49 offen offset:2048 nt lds
    buffer_load_dwordx4 v203, s[20:23], s49 offen offset:3072 nt lds
    s_add_u32 m0, s48, 12288
    s_add_u32 s63, s49, 4096
    buffer_load_dwordx4 v200, s[20:23], s63 offen offset:0 nt lds
    buffer_load_dwordx4 v201, s[20:23], s63 offen offset:1024 nt lds
    buffer_load_dwordx4 v202, s[20:23], s63 offen offset:2048 nt lds
    buffer_load_dwordx4 v203, s[20:23], s63 offen offset:3072 nt lds
    s_add_u32 s49, s49, 32768
    s_and_b32 s49, s49, 0x7ffff
    s_waitcnt vmcnt(8)
    s_barrier
    s_cmp_lg_u32 s3, 0
    s_cbranch_scc1 L_noflag_1
    s_lshl_b32 s52, s2, 7
    s_add_u32 s52, s52, 0
    v_mov_b32 v2, s52
    v_mov_b32 v3, s56
    s_mov_b64 exec, 1
    buffer_store_dword v3, v2, s[40:43], 0 offen sc1
    s_mov_b64 exec, -1
L_noflag_1:
    s_add_u32 m0, s48, 16384
    s_nop 0
    buffer_load_dwordx4 v200, s[24:27], s50 offen offset:0 nt lds
    buffer_load_dwordx4 v201, s[24:27], s50 offen offset:1024 nt lds
    buffer_load_dwordx4 v202, s[24:27], s50 offen offset:2048 nt lds
    buffer_load_dwordx4 v203, s[24:27], s50 offen offset:3072 nt lds
    s_add_u32 m0, s48, 20480
    s_add_u32 s63, s50, 4096
    buffer_load_dwordx4 v200, s[24:27], s63 offen offset:0 nt lds
    buffer_load_dwordx4 v201, s[24:27], s63 offen offset:1024 nt lds
    buffer_load_dwordx4 v202, s[24:27], s63 offen offset:2048 nt lds
    buffer_load_dwordx4 v203, s[24:27], s63 offen offset:3072 nt lds
    s_add_u32 s50, s50, 32768
    s_and_b32 s50, s50, 0x7ffff
    s_waitcnt vmcnt(18)
    ds_read_b64_tr_b16 v[160:161], v212 offset:0
    ds_read_b64_tr_b16 v[162:163], v213 offset:2048
    ds_read_b64_tr_b16 v[164:165], v212 offset:4096
    ds_read_b64_tr_b16 v[166:167], v213 offset:6144
    ds_read_b64_tr_b16 v[168:169], v214 offset:0
    ds_read_b64_tr_b16 v[170:171], v215 offset:2048
    ds_read_b64_tr_b16 v[172:173], v214 offset:4096
    ds_read_b64_tr_b16 v[174:175], v215 offset:6144
    ds_read_b64_tr_b16 v[176:177], v216 offset:0
    ds_read_b64_tr_b16 v[178:179], v217 offset:2048
    ds_read_b64_tr_b16 v[180:181], v216 offset:4096
    ds_read_b64_tr_b16 v[182:183], v217 offset:6144
    ds_read_b64_tr_b16 v[184:185], v218 offset:0
    ds_read_b64_tr_b16 v[186:187], v219 offset:2048
    ds_read_b64_tr_b16 v[188:189], v218 offset:4096
    ds_read_b64_tr_b16 v[190:191], v219 offset:6144
    s_waitcnt lgkmcnt(0)
    s_add_u32 m0, s48, 0
    s_nop 0
    buffer_load_dwordx4 v200, s[20:23], s49 offen offset:0 nt lds
    buffer_load_dwordx4 v201, s[20:23], s49 offen offset:1024 nt lds
    buffer_load_dwordx4 v202, s[20:23], s49 offen offset:2048 nt lds
    buffer_load_dwordx4 v203, s[20:23], s49 offen offset:3072 nt lds
    s_add_u32 m0, s48, 4096
    s_add_u32 s63, s49, 4096
    buffer_load_dwordx4 v200, s[20:23], s63 offen offset:0 nt lds
    buffer_load_dwordx4 v201, s[20:23], s63 offen offset:1024 nt lds
    buffer_load_dwordx4 v202, s[20:23], s63 offen offset:2048 nt lds
    buffer_load_dwordx4 v203, s[20:23], s63 offen offset:3072 nt lds
    s_add_u32 s49, s49, 32768
    s_and_b32 s49, s49, 0x7ffff
    v_and_b32 v2, 3, v0
    v_lshlrev_b32 v2, 7, v2
    buffer_load_dword v224, v2, s[40:43], s87 offen nt
    v_mov_b32 v226, 0xff800000
    v_mov_b32 v227, 0
    v_mov_b32 v48, 0
    v_mov_b32 v49, 0
    v_mov_b32 v50, 0
    v_mov_b32 v51, 0
    v_mov_b32 v52, 0
    v_mov_b32 v53, 0
    v_mov_b32 v54, 0
    v_mov_b32 v55, 0
    v_mov_b32 v56, 0
    v_mov_b32 v57, 0
    v_mov_b32 v58, 0
    v_mov_b32 v59, 0
    v_mov_b32 v60, 0
    v_mov_b32 v61, 0
    v_mov_b32 v62, 0
    v_mov_b32 v63, 0
    v_mov_b32 v64, 0
    v_mov_b32 v65, 0
    v_mov_b32 v66, 0
    v_mov_b32 v67, 0
    v_mov_b32 v68, 0
    v_mov_b32 v69, 0
    v_mov_b32 v70, 0
    v_mov_b32 v71, 0
    v_mov_b32 v72, 0
    v_mov_b32 v73, 0
    v_mov_b32 v74, 0
    v_mov_b32 v75, 0
    v_mov_b32 v76, 0
    v_mov_b32 v77, 0
    v_mov_b32 v78, 0
    v_mov_b32 v79, 0
    v_mov_b32 v80, 0
    v_mov_b32 v81, 0
    v_mov_b32 v82, 0
    v_mov_b32 v83, 0
    v_mov_b32 v84, 0
    v_mov_b32 v85, 0
    v_mov_b32 v86, 0
    v_mov_b32 v87, 0
    v_mov_b32 v88, 0
    v_mov_b32 v89, 0
    v_mov_b32 v90, 0
    v_mov_b32 v91, 0
    v_mov_b32 v92, 0
    v_mov_b32 v93, 0
    v_mov_b32 v94, 0
    v_mov_b32 v95, 0
    v_mov_b32 v96, 0
    v_mov_b32 v97, 0
    v_mov_b32 v98, 0
    v_mov_b32 v99, 0
    v_mov_b32 v100, 0
    v_mov_b32 v101, 0
    v_mov_b32 v102, 0
    v_mov_b32 v103, 0
    v_mov_b32 v104, 0
    v_mov_b32 v105, 0
    v_mov_b32 v106, 0
    v_mov_b32 v107, 0
    v_mov_b32 v108, 0
    v_mov_b32 v109, 0
    v_mov_b32 v110, 0
    v_mov_b32 v111, 0
    s_waitcnt vmcnt(17)
    ds_read_b128 a[192:195], v204 offset:8192
    ds_read_b128 a[196:199], v205 offset:8192
    ds_read_b128 a[200:203], v206 offset:8192
    ds_read_b128 a[204:207], v207 offset:8192
    ds_read_b128 a[208:211], v208 offset:8192
    ds_read_b128 a[212:215], v209 offset:8192
    ds_read_b128 a[216:219], v210 offset:8192
    ds_read_b128 a[220:223], v211 offset:8192
    s_cmp_lg_u32 s57, 0
    s_cbranch_scc1 L_np_2
    buffer_load_dword v220, v221, s[40:43], 0 offen sc1
L_np_2:
    s_add_u32 m0, s48, 24576
    s_nop 0
    buffer_load_dwordx4 v200, s[24:27], s50 offen offset:0 nt lds
    buffer_load_dwordx4 v201, s[24:27], s50 offen offset:1024 nt lds
    buffer_load_dwordx4 v202, s[24:27], s50 offen offset:2048 nt lds
    buffer_load_dwordx4 v203, s[24:27], s50 offen offset:3072 nt lds
    s_add_u32 m0, s48, 28672
    s_add_u32 s63, s50, 4096
    buffer_load_dwordx4 v200, s[24:27], s63 offen offset:0 nt lds
    buffer_load_dwordx4 v201, s[24:27], s63 offen offset:1024 nt lds
    buffer_load_dwordx4 v202, s[24:27], s63 offen offset:2048 nt lds
    buffer_load_dwordx4 v203, s[24:27], s63 offen offset:3072 nt lds
    s_add_u32 s50, s50, 32768
    s_and_b32 s50, s50, 0x7ffff
    s_cmp_eq_u32 s57, 2
    s_cbranch_scc1 L_nx_4
    s_waitcnt vmcnt(8)
    s_cmp_eq_u32 s57, 1
    s_cbranch_scc1 L_st1_3
    v_cmp_ne_u32 vcc, s56, v220
    s_cbranch_vccnz L_nx_4
    s_add_u32 s54, s80, 4096
    buffer_load_dwordx4 v[16:19], v240, s[40:43], s80 offen offset:0 sc1
    buffer_load_dwordx4 v[20:23], v240, s[40:43], s80 offen offset:1024 sc1
    buffer_load_dwordx4 v[24:27], v240, s[40:43], s80 offen offset:2048 sc1
    buffer_load_dwordx4 v[28:31], v240, s[40:43], s80 offen offset:3072 sc1
    buffer_load_dwordx4 v[32:35], v240, s[40:43], s54 offen offset:0 sc1
    buffer_load_dwordx4 v[36:39], v240, s[40:43], s54 offen offset:1024 sc1
    buffer_load_dwordx4 v[40:43], v240, s[40:43], s54 offen offset:2048 sc1
    buffer_load_dwordx4 v[44:47], v240, s[40:43], s54 offen offset:3072 sc1
    s_cmp_eq_u32 s95, 0
    s_cbranch_scc1 L_nopw_5
    buffer_load_dword v222, v223, s[40:43], 0 offen sc1
L_nopw_5:
    s_mov_b32 s57, 1
    s_branch L_nx_4
L_st1_3:
    s_mov_b32 s57, 2
L_nx_4:
    s_waitcnt lgkmcnt(0)
    s_cmp_lg_u32 s57, 0
    s_cbranch_scc1 L_np_6
    buffer_load_dword v220, v221, s[40:43], 0 offen sc1
L_np_6:
    s_add_u32 m0, s48, 8192
    s_nop 0
    buffer_load_dwordx4 v200, s[20:23], s49 offen offset:0 nt lds
    buffer_load_dwordx4 v201, s[20:23], s49 offen offset:1024 nt lds
    buffer_load_dwordx4 v202, s[20:23], s49 offen offset:2048 nt lds
    buffer_load_dwordx4 v203, s[20:23], s49 offen offset:3072 nt lds
    s_add_u32 m0, s48, 12288
    s_add_u32 s63, s49, 4096
    buffer_load_dwordx4 v200, s[20:23], s63 offen offset:0 nt lds
    buffer_load_dwordx4 v201, s[20:23], s63 offen offset:1024 nt lds
    buffer_load_dwordx4 v202, s[20:23], s63 offen offset:2048 nt lds
    buffer_load_dwordx4 v203, s[20:23], s63 offen offset:3072 nt lds
    s_add_u32 s49, s49, 32768
    s_and_b32 s49, s49, 0x7ffff
    s_cmp_eq_u32 s57, 2
    s_cbranch_scc1 L_nx_8
    s_waitcnt vmcnt(8)
    s_cmp_eq_u32 s57, 1
    s_cbranch_scc1 L_st1_7
    v_cmp_ne_u32 vcc, s56, v220
    s_cbranch_vccnz L_nx_8
    s_add_u32 s54, s80, 4096
    buffer_load_dwordx4 v[16:19], v240, s[40:43], s80 offen offset:0 sc1
    buffer_load_dwordx4 v[20:23], v240, s[40:43], s80 offen offset:1024 sc1
    buffer_load_dwordx4 v[24:27], v240, s[40:43], s80 offen offset:2048 sc1
    buffer_load_dwordx4 v[28:31], v240, s[40:43], s80 offen offset:3072 sc1
    buffer_load_dwordx4 v[32:35], v240, s[40:43], s54 offen offset:0 sc1
    buffer_load_dwordx4 v[36:39], v240, s[40:43], s54 offen offset:1024 sc1
    buffer_load_dwordx4 v[40:43], v240, s[40:43], s54 offen offset:2048 sc1
    buffer_load_dwordx4 v[44:47], v240, s[40:43], s54 offen offset:3072 sc1
    s_cmp_eq_u32 s95, 0
    s_cbranch_scc1 L_nopw_9
    buffer_load_dword v222, v223, s[40:43], 0 offen sc1
L_nopw_9:
    s_mov_b32 s57, 1
    s_branch L_nx_8
L_st1_7:
    s_mov_b32 s57, 2
L_nx_8:
    s_waitcnt vmcnt(25)
    ds_read_b64_tr_b16 a[224:225], v212 offset:16384
    ds_read_b64_tr_b16 a[226:227], v213 offset:18432
    ds_read_b64_tr_b16 a[228:229], v212 offset:20480
    ds_read_b64_tr_b16 a[230:231], v213 offset:22528
    ds_read_b64_tr_b16 a[232:233], v214 offset:16384
    ds_read_b64_tr_b16 a[234:235], v215 offset:18432
    ds_read_b64_tr_b16 a[236:237], v214 offset:20480
    ds_read_b64_tr_b16 a[238:239], v215 offset:22528
    ds_read_b64_tr_b16 a[240:241], v216 offset:16384
    ds_read_b64_tr_b16 a[242:243], v217 offset:18432
    ds_read_b64_tr_b16 a[244:245], v216 offset:20480
    ds_read_b64_tr_b16 a[246:247], v217 offset:22528
    ds_read_b64_tr_b16 a[248:249], v218 offset:16384
    ds_read_b64_tr_b16 a[250:251], v219 offset:18432
    ds_read_b64_tr_b16 a[252:253], v218 offset:20480
    ds_read_b64_tr_b16 a[254:255], v219 offset:22528
    s_waitcnt lgkmcnt(0)
    s_cmp_lg_u32 s57, 0
    s_cbranch_scc1 L_np_10
    buffer_load_dword v220, v221, s[40:43], 0 offen sc1
L_np_10:
    s_add_u32 m0, s48, 16384
    s_nop 0
    buffer_load_dwordx4 v200, s[24:27], s50 offen offset:0 nt lds
    buffer_load_dwordx4 v201, s[24:27], s50 offen offset:1024 nt lds
    buffer_load_dwordx4 v202, s[24:27], s50 offen offset:2048 nt lds
    buffer_load_dwordx4 v203, s[24:27], s50 offen offset:3072 nt lds
    s_add_u32 m0, s48, 20480
    s_add_u32 s63, s50, 4096
    buffer_load_dwordx4 v200, s[24:27], s63 offen offset:0 nt lds
    buffer_load_dwordx4 v201, s[24:27], s63 offen offset:1024 nt lds
    buffer_load_dwordx4 v202, s[24:27], s63 offen offset:2048 nt lds
    buffer_load_dwordx4 v203, s[24:27], s63 offen offset:3072 nt lds
    s_add_u32 s50, s50, 32768
    s_and_b32 s50, s50, 0x7ffff
    s_cmp_eq_u32 s57, 2
    s_cbranch_scc1 L_nx_12
    s_waitcnt vmcnt(8)
    s_cmp_eq_u32 s57, 1
    s_cbranch_scc1 L_st1_11
    v_cmp_ne_u32 vcc, s56, v220
    s_cbranch_vccnz L_nx_12
    s_add_u32 s54, s80, 4096
    buffer_load_dwordx4 v[16:19], v240, s[40:43], s80 offen offset:0 sc1
    buffer_load_dwordx4 v[20:23], v240, s[40:43], s80 offen offset:1024 sc1
    buffer_load_dwordx4 v[24:27], v240, s[40:43], s80 offen offset:2048 sc1
    buffer_load_dwordx4 v[28:31], v240, s[40:43], s80 offen offset:3072 sc1
    buffer_load_dwordx4 v[32:35], v240, s[40:43], s54 offen offset:0 sc1
    buffer_load_dwordx4 v[36:39], v240, s[40:43], s54 offen offset:1024 sc1
    buffer_load_dwordx4 v[40:43], v240, s[40:43], s54 offen offset:2048 sc1
    buffer_load_dwordx4 v[44:47], v240, s[40:43], s54 offen offset:3072 sc1
    s_cmp_eq_u32 s95, 0
    s_cbranch_scc1 L_nopw_13
    buffer_load_dword v222, v223, s[40:43], 0 offen sc1
L_nopw_13:
    s_mov_b32 s57, 1
    s_branch L_nx_12
L_st1_11:
    s_mov_b32 s57, 2
L_nx_12:
    s_cmp_eq_u32 s57, 2
    s_cbranch_scc1 L_qdone_14
    s_cmp_eq_u32 s57, 1
    s_cbranch_scc1 L_qwait_16
    s_mov_b32 s58, 400000
L_qpoll_15:
    buffer_load_dword v220, v221, s[40:43], 0 offen sc1
    s_sub_u32 s58, s58, 1
    s_cmp_eq_u32 s58, 0
    s_cbranch_scc1 L_end
    s_waitcnt vmcnt(0)
    v_cmp_ne_u32 vcc, s56, v220
    s_cbranch_vccnz L_qpoll_15
    s_add_u32 s54, s80, 4096
    buffer_load_dwordx4 v[16:19], v240, s[40:43], s80 offen offset:0 sc1
    buffer_load_dwordx4 v[20:23], v240, s[40:43], s80 offen offset:1024 sc1
    buffer_load_dwordx4 v[24:27], v240, s[40:43], s80 offen offset:2048 sc1
    buffer_load_dwordx4 v[28:31], v240, s[40:43], s80 offen offset:3072 sc1
    buffer_load_dwordx4 v[32:35], v240, s[40:43], s54 offen offset:0 sc1
    buffer_load_dwordx4 v[36:39], v240, s[40:43], s54 offen offset:1024 sc1
    buffer_load_dwordx4 v[40:43], v240, s[40:43], s54 offen offset:2048 sc1
    buffer_load_dwordx4 v[44:47], v240, s[40:43], s54 offen offset:3072 sc1
    s_cmp_eq_u32 s95, 0
    s_cbranch_scc1 L_nopw_17
    buffer_load_dword v222, v223, s[40:43], 0 offen sc1
L_nopw_17:
L_qwait_16:
    s_waitcnt vmcnt(0)
L_qdone_14:
    v_mfma_f32_32x32x16_bf16 v[112:127], v[128:131], v[16:19], 0
    v_mfma_f32_32x32x16_bf16 v[112:127], v[132:135], v[20:23], v[112:127]
    v_mfma_f32_32x32x16_bf16 v[112:127], v[136:139], v[24:27], v[112:127]
    v_mfma_f32_32x32x16_bf16 v[112:127], v[140:143], v[28:31], v[112:127]
    v_mfma_f32_32x32x16_bf16 v[112:127], v[144:147], v[32:35], v[112:127]
    v_mfma_f32_32x32x16_bf16 v[112:127], v[148:151], v[36:39], v[112:127]
    v_mfma_f32_32x32x16_bf16 v[112:127], v[152:155], v[40:43], v[112:127]
    v_mfma_f32_32x32x16_bf16 v[112:127], v[156:159], v[44:47], v[112:127]
    s_nop 7
    s_nop 3
    v_max3_f32 v228, v112, v113, v114
    v_max3_f32 v228, v228, v115, v116
    v_max3_f32 v228, v228, v117, v118
    v_max3_f32 v228, v228, v119, v120
    v_max3_f32 v228, v228, v121, v122
    v_max3_f32 v228, v228, v123, v124
    v_max3_f32 v228, v228, v125, v126
    v_max_f32 v228, v228, v127
    v_mov_b32 v229, v228
    s_nop 1
    v_permlane32_swap_b32 v228, v229
    s_nop 1
    v_max3_f32 v228, v228, v229, v226
    v_sub_f32 v231, v226, v228
    v_mul_f32 v231, s55, v231
    v_exp_f32 v231, v231
    v_mul_f32 v232, s55, v228
    v_mov_b32 v226, v228
    v_fma_f32 v112, v112, s55, -v232
    v_fma_f32 v113, v113, s55, -v232
    v_fma_f32 v114, v114, s55, -v232
    v_fma_f32 v115, v115, s55, -v232
    v_fma_f32 v116, v116, s55, -v232
    v_fma_f32 v117, v117, s55, -v232
    v_fma_f32 v118, v118, s55, -v232
    v_fma_f32 v119, v119, s55, -v232
    v_fma_f32 v120, v120, s55, -v232
    v_fma_f32 v121, v121, s55, -v232
    v_fma_f32 v122, v122, s55, -v232
    v_fma_f32 v123, v123, s55, -v232
    v_fma_f32 v124, v124, s55, -v232
    v_fma_f32 v125, v125, s55, -v232
    v_fma_f32 v126, v126, s55, -v232
    v_fma_f32 v127, v127, s55, -v232
    v_exp_f32 v112, v112
    v_exp_f32 v113, v113
    v_exp_f32 v114, v114
    v_exp_f32 v115, v115
    v_exp_f32 v116, v116
    v_exp_f32 v117, v117
    v_exp_f32 v118, v118
    v_exp_f32 v119, v119
    v_exp_f32 v120, v120
    v_exp_f32 v121, v121
    v_exp_f32 v122, v122
    v_exp_f32 v123, v123
    v_exp_f32 v124, v124
    v_exp_f32 v125, v125
    v_exp_f32 v126, v126
    v_exp_f32 v127, v127
    v_mul_f32 v227, v227, v231
    v_mul_f32 v48, v48, v231
    v_mul_f32 v49, v49, v231
    v_mul_f32 v50, v50, v231
    v_mul_f32 v51, v51, v231
    v_mul_f32 v52, v52, v231
    v_mul_f32 v53, v53, v231
    v_mul_f32 v54, v54, v231
    v_mul_f32 v55, v55, v231
    v_mul_f32 v56, v56, v231
    v_mul_f32 v57, v57, v231
    v_mul_f32 v58, v58, v231
    v_mul_f32 v59, v59, v231
    v_mul_f32 v60, v60, v231
    v_mul_f32 v61, v61, v231
    v_mul_f32 v62, v62, v231
    v_mul_f32 v63, v63, v231
    v_mul_f32 v64, v64, v231
    v_mul_f32 v65, v65, v231
    v_mul_f32 v66, v66, v231
    v_mul_f32 v67, v67, v231
    v_mul_f32 v68, v68, v231
    v_mul_f32 v69, v69, v231
    v_mul_f32 v70, v70, v231
    v_mul_f32 v71, v71, v231
    v_mul_f32 v72, v72, v231
    v_mul_f32 v73, v73, v231
    v_mul_f32 v74, v74, v231
    v_mul_f32 v75, v75, v231
    v_mul_f32 v76, v76, v231
    v_mul_f32 v77, v77, v231
    v_mul_f32 v78, v78, v231
    v_mul_f32 v79, v79, v231
    v_mul_f32 v80, v80, v231
    v_mul_f32 v81, v81, v231
    v_mul_f32 v82, v82, v231
    v_mul_f32 v83, v83, v231
    v_mul_f32 v84, v84, v231
    v_mul_f32 v85, v85, v231
    v_mul_f32 v86, v86, v231
    v_mul_f32 v87, v87, v231
    v_mul_f32 v88, v88, v231
    v_mul_f32 v89, v89, v231
    v_mul_f32 v90, v90, v231
    v_mul_f32 v91, v91, v231
    v_mul_f32 v92, v92, v231
    v_mul_f32 v93, v93, v231
    v_mul_f32 v94, v94, v231
    v_mul_f32 v95, v95, v231
    v_mul_f32 v96, v96, v231
    v_mul_f32 v97, v97, v231
    v_mul_f32 v98, v98, v231
    v_mul_f32 v99, v99, v231
    v_mul_f32 v100, v100, v231
    v_mul_f32 v101, v101, v231
    v_mul_f32 v102, v102, v231
    v_mul_f32 v103, v103, v231
    v_mul_f32 v104, v104, v231
    v_mul_f32 v105, v105, v231
    v_mul_f32 v106, v106, v231
    v_mul_f32 v107, v107, v231
    v_mul_f32 v108, v108, v231
    v_mul_f32 v109, v109, v231
    v_mul_f32 v110, v110, v231
    v_mul_f32 v111, v111, v231
    v_add_f32 v227, v227, v112
    v_add_f32 v227, v227, v113
    v_add_f32 v227, v227, v114
    v_add_f32 v227, v227, v115
    v_add_f32 v227, v227, v116
    v_add_f32 v227, v227, v117
    v_add_f32 v227, v227, v118
    v_add_f32 v227, v227, v119
    v_add_f32 v227, v227, v120
    v_add_f32 v227, v227, v121
    v_add_f32 v227, v227, v122
    v_add_f32 v227, v227, v123
    v_add_f32 v227, v227, v124
    v_add_f32 v227, v227, v125
    v_add_f32 v227, v227, v126
    v_add_f32 v227, v227, v127
    v_cvt_pk_bf16_f32 v192, v112, v113
    v_cvt_pk_bf16_f32 v193, v114, v115
    v_cvt_pk_bf16_f32 v194, v116, v117
    v_cvt_pk_bf16_f32 v195, v118, v119
    v_cvt_pk_bf16_f32 v196, v120, v121
    v_cvt_pk_bf16_f32 v197, v122, v123
    v_cvt_pk_bf16_f32 v198, v124, v125
    v_cvt_pk_bf16_f32 v199, v126, v127
    s_nop 1
    v_mfma_f32_32x32x16_bf16 v[48:63], v[160:163], v[192:195], v[48:63]
    v_mfma_f32_32x32x16_bf16 v[48:63], v[164:167], v[196:199], v[48:63]
    v_mfma_f32_32x32x16_bf16 v[64:79], v[168:171], v[192:195], v[64:79]
    v_mfma_f32_32x32x16_bf16 v[64:79], v[172:175], v[196:199], v[64:79]
    v_mfma_f32_32x32x16_bf16 v[80:95], v[176:179], v[192:195], v[80:95]
    v_mfma_f32_32x32x16_bf16 v[80:95], v[180:183], v[196:199], v[80:95]
    v_mfma_f32_32x32x16_bf16 v[96:111], v[184:187], v[192:195], v[96:111]
    v_mfma_f32_32x32x16_bf16 v[96:111], v[188:191], v[196:199], v[96:111]
    s_mov_b32 s59, 0
L_main:
    s_or_b32 s52, s2, s3
    s_cmp_lg_u32 s52, 0
    s_cbranch_scc1 L_epx_21
    s_cmp_eq_u32 s59, 3
    s_cbranch_scc1 L_ep3_19
    s_cmp_lg_u32 s59, 2
    s_cbranch_scc1 L_epx_21
    v_lshlrev_b32 v8, 7, v0
    v_add_u32 v8, 0, v8
    v_add_u32 v9, 16384, v8
    s_mov_b32 s54, 8192
    buffer_load_dword v10, v8, s[40:43], 0 offen sc1
    buffer_load_dword v11, v9, s[40:43], 0 offen sc1
    buffer_load_dword v12, v8, s[40:43], s54 offen sc1
    buffer_load_dword v13, v9, s[40:43], s54 offen sc1
    s_branch L_epx_21
L_ep3_19:
    v_xor_b32 v10, s56, v10
    v_xor_b32 v11, s56, v11
    v_xor_b32 v12, s56, v12
    v_xor_b32 v13, s56, v13
    v_or_b32 v10, v10, v11
    v_or3_b32 v10, v10, v12, v13
    v_cmp_ne_u32 vcc, 0, v10
    s_cbranch_vccz L_ep2_18
    s_mov_b32 s58, 400000
    s_mov_b32 s54, 8192
L_epp_20:
    buffer_load_dword v10, v8, s[40:43], 0 offen sc1
    buffer_load_dword v11, v9, s[40:43], 0 offen sc1
    buffer_load_dword v12, v8, s[40:43], s54 offen sc1
    buffer_load_dword v13, v9, s[40:43], s54 offen sc1
    s_sub_u32 s58, s58, 1
    s_cmp_eq_u32 s58, 0
    s_cbranch_scc1 L_end
    s_waitcnt vmcnt(0)
    v_xor_b32 v10, s56, v10
    v_xor_b32 v11, s56, v11
    v_xor_b32 v12, s56, v12
    v_xor_b32 v13, s56, v13
    v_or_b32 v10, v10, v11
    v_or3_b32 v10, v10, v12, v13
    v_cmp_ne_u32 vcc, 0, v10
    s_cbranch_vccnz L_epp_20
L_ep2_18:
    v_mov_b32 v10, 131072
    v_mov_b32 v11, s56
    s_mov_b64 exec, 1
    buffer_store_dword v11, v10, s[40:43], 0 offen sc1
    s_mov_b64 exec, -1
L_epx_21:
    s_barrier
    s_waitcnt vmcnt(24)
    ds_read_b128 v[128:131], v204 offset:0
    ds_read_b128 v[132:135], v205 offset:0
    ds_read_b128 v[136:139], v206 offset:0
    ds_read_b128 v[140:143], v207 offset:0
    ds_read_b128 v[144:147], v208 offset:0
    ds_read_b128 v[148:151], v209 offset:0
    ds_read_b128 v[152:155], v210 offset:0
    ds_read_b128 v[156:159], v211 offset:0
    s_waitcnt lgkmcnt(7)
    v_mfma_f32_32x32x16_bf16 v[112:127], v[128:131], v[16:19], 0
    s_waitcnt lgkmcnt(6)
    v_mfma_f32_32x32x16_bf16 v[112:127], v[132:135], v[20:23], v[112:127]
    s_waitcnt lgkmcnt(5)
    v_mfma_f32_32x32x16_bf16 v[112:127], v[136:139], v[24:27], v[112:127]
    s_waitcnt lgkmcnt(4)
    v_mfma_f32_32x32x16_bf16 v[112:127], v[140:143], v[28:31], v[112:127]
    s_waitcnt lgkmcnt(3)
    v_mfma_f32_32x32x16_bf16 v[112:127], v[144:147], v[32:35], v[112:127]
    s_waitcnt lgkmcnt(2)
    v_mfma_f32_32x32x16_bf16 v[112:127], v[148:151], v[36:39], v[112:127]
    s_waitcnt lgkmcnt(1)
    v_mfma_f32_32x32x16_bf16 v[112:127], v[152:155], v[40:43], v[112:127]
    s_waitcnt lgkmcnt(0)
    v_mfma_f32_32x32x16_bf16 v[112:127], v[156:159], v[44:47], v[112:127]
    s_cmp_eq_u32 s59, 1
    s_cbranch_scc1 L_pt0_23
    s_cmp_eq_u32 s59, 2
    s_cbranch_scc1 L_pt4_24
    s_cmp_eq_u32 s59, 3
    s_cbranch_scc1 L_pt8_25
    s_cmp_eq_u32 s59, 4
    s_cbranch_scc1 L_pt12_26
    s_cmp_eq_u32 s59, 5
    s_cbranch_scc1 L_pt16_27
    s_waitcnt vmcnt(8)
    s_add_u32 m0, s48, 0
    s_nop 0
    buffer_load_dwordx4 v200, s[20:23], s49 offen offset:0 nt lds
    buffer_load_dwordx4 v201, s[20:23], s49 offen offset:1024 nt lds
    buffer_load_dwordx4 v202, s[20:23], s49 offen offset:2048 nt lds
    buffer_load_dwordx4 v203, s[20:23], s49 offen offset:3072 nt lds
    s_waitcnt vmcnt(8)
    s_add_u32 m0, s48, 4096
    s_add_u32 s63, s49, 4096
    buffer_load_dwordx4 v200, s[20:23], s63 offen offset:0 nt lds
    buffer_load_dwordx4 v201, s[20:23], s63 offen offset:1024 nt lds
    buffer_load_dwordx4 v202, s[20:23], s63 offen offset:2048 nt lds
    buffer_load_dwordx4 v203, s[20:23], s63 offen offset:3072 nt lds
    s_add_u32 s49, s49, 32768
    s_and_b32 s49, s49, 0x7ffff
    s_branch L_ptd_22
L_pt0_23:
    s_cmp_eq_u32 s95, 0
    s_cbranch_scc1 L_wdone_30
    v_cmp_ne_u32 vcc, s56, v222
    s_cbranch_vccz L_wdone_30
    s_mov_b32 s58, 400000
L_wpoll_29:
    buffer_load_dword v222, v223, s[40:43], 0 offen sc1
    s_sub_u32 s58, s58, 1
    s_cmp_eq_u32 s58, 0
    s_cbranch_scc1 L_end
    s_waitcnt vmcnt(0)
    v_cmp_ne_u32 vcc, s56, v222
    s_cbranch_vccnz L_wpoll_29
L_wdone_30:
    s_add_u32 m0, s48, 32768
    s_nop 0
    buffer_load_dwordx4 v241, s[36:39], s51 offen sc1 lds
    s_add_u32 s51, s51, s94
    s_add_u32 m0, s48, 33792
    s_nop 0
    buffer_load_dwordx4 v241, s[36:39], s51 offen sc1 lds
    s_add_u32 s51, s51, s94
    s_add_u32 m0, s48, 34816
    s_nop 0
    buffer_load_dwordx4 v241, s[36:39], s51 offen sc1 lds
    s_add_u32 s51, s51, s94
    s_add_u32 m0, s48, 35840
    s_nop 0
    buffer_load_dwordx4 v241, s[36:39], s51 offen sc1 lds
    s_add_u32 s51, s51, s94
    s_branch L_ptkv_28
L_pt4_24:
    s_waitcnt vmcnt(20)
    ds_read_b64_tr_b16 a[32:33], v242 offset:32768
    ds_read_b64_tr_b16 a[34:35], v242 offset:33024
    ds_read_b64_tr_b16 a[36:37], v243 offset:32768
    ds_read_b64_tr_b16 a[38:39], v243 offset:33024
    ds_read_b64_tr_b16 a[40:41], v242 offset:34816
    ds_read_b64_tr_b16 a[42:43], v242 offset:35072
    ds_read_b64_tr_b16 a[44:45], v243 offset:34816
    ds_read_b64_tr_b16 a[46:47], v243 offset:35072
    s_waitcnt lgkmcnt(0)
    s_add_u32 m0, s48, 32768
    s_nop 0
    buffer_load_dwordx4 v241, s[36:39], s51 offen sc1 lds
    s_add_u32 s51, s51, s94
    s_add_u32 m0, s48, 33792
    s_nop 0
    buffer_load_dwordx4 v241, s[36:39], s51 offen sc1 lds
    s_add_u32 s51, s51, s94
    s_add_u32 m0, s48, 34816
    s_nop 0
    buffer_load_dwordx4 v241, s[36:39], s51 offen sc1 lds
    s_add_u32 s51, s51, s94
    s_add_u32 m0, s48, 35840
    s_nop 0
    buffer_load_dwordx4 v241, s[36:39], s51 offen sc1 lds
    s_add_u32 s51, s51, s94
    s_branch L_ptkv_28
L_pt8_25:
    s_waitcnt vmcnt(20)
    ds_read_b64_tr_b16 a[96:97], v242 offset:32768
    ds_read_b64_tr_b16 a[98:99], v242 offset:33024
    ds_read_b64_tr_b16 a[100:101], v243 offset:32768
    ds_read_b64_tr_b16 a[102:103], v243 offset:33024
    ds_read_b64_tr_b16 a[104:105], v242 offset:34816
    ds_read_b64_tr_b16 a[106:107], v242 offset:35072
    ds_read_b64_tr_b16 a[108:109], v243 offset:34816
    ds_read_b64_tr_b16 a[110:111], v243 offset:35072
    s_waitcnt lgkmcnt(0)
    s_add_u32 m0, s48, 32768
    s_nop 0
    buffer_load_dwordx4 v241, s[36:39], s51 offen sc1 lds
    s_add_u32 s51, s51, s94
    s_add_u32 m0, s48, 33792
    s_nop 0
    buffer_load_dwordx4 v241, s[36:39], s51 offen sc1 lds
    s_add_u32 s51, s51, s94
    s_add_u32 m0, s48, 34816
    s_nop 0
    buffer_load_dwordx4 v241, s[36:39], s51 offen sc1 lds
    s_add_u32 s51, s51, s94
    s_add_u32 m0, s48, 35840
    s_nop 0
    buffer_load_dwordx4 v241, s[36:39], s51 offen sc1 lds
    s_add_u32 s51, s51, s94
    s_branch L_ptkv_28
L_pt12_26:
    s_waitcnt vmcnt(20)
    ds_read_b64_tr_b16 a[160:161], v242 offset:32768
    ds_read_b64_tr_b16 a[162:163], v242 offset:33024
    ds_read_b64_tr_b16 a[164:165], v243 offset:32768
    ds_read_b64_tr_b16 a[166:167], v243 offset:33024
    ds_read_b64_tr_b16 a[168:169], v242 offset:34816
    ds_read_b64_tr_b16 a[170:171], v242 offset:35072
    ds_read_b64_tr_b16 a[172:173], v243 offset:34816
    ds_read_b64_tr_b16 a[174:175], v243 offset:35072
    s_waitcnt lgkmcnt(0)
    s_add_u32 m0, s48, 32768
    s_nop 0
    buffer_load_dwordx4 v241, s[36:39], s51 offen sc1 lds
    s_add_u32 s51, s51, s94
    s_add_u32 m0, s48, 33792
    s_nop 0
    buffer_load_dwordx4 v241, s[36:39], s51 offen sc1 lds
    s_add_u32 s51, s51, s94
    s_add_u32 m0, s48, 34816
    s_nop 0
    buffer_load_dwordx4 v241, s[36:39], s51 offen sc1 lds
    s_add_u32 s51, s51, s94
    s_add_u32 m0, s48, 35840
    s_nop 0
    buffer_load_dwordx4 v241, s[36:39], s51 offen sc1 lds
    s_add_u32 s51, s51, s94
    s_branch L_ptkv_28
L_pt16_27:
    s_waitcnt vmcnt(20)
    ds_read_b64_tr_b16 a[224:225], v242 offset:32768
    ds_read_b64_tr_b16 a[226:227], v242 offset:33024
    ds_read_b64_tr_b16 a[228:229], v243 offset:32768
    ds_read_b64_tr_b16 a[230:231], v243 offset:33024
    ds_read_b64_tr_b16 a[232:233], v242 offset:34816
    ds_read_b64_tr_b16 a[234:235], v242 offset:35072
    ds_read_b64_tr_b16 a[236:237], v243 offset:34816
    ds_read_b64_tr_b16 a[238:239], v243 offset:35072
    s_waitcnt lgkmcnt(0)
L_ptkv_28:
    s_add_u32 m0, s48, 0
    s_nop 0
    buffer_load_dwordx4 v200, s[20:23], s49 offen offset:0 nt lds
    buffer_load_dwordx4 v201, s[20:23], s49 offen offset:1024 nt lds
    buffer_load_dwordx4 v202, s[20:23], s49 offen offset:2048 nt lds
    buffer_load_dwordx4 v203, s[20:23], s49 offen offset:3072 nt lds
    s_add_u32 m0, s48, 4096
    s_add_u32 s63, s49, 4096
    buffer_load_dwordx4 v200, s[20:23], s63 offen offset:0 nt lds
    buffer_load_dwordx4 v201, s[20:23], s63 offen offset:1024 nt lds
    buffer_load_dwordx4 v202, s[20:23], s63 offen offset:2048 nt lds
    buffer_load_dwordx4 v203, s[20:23], s63 offen offset:3072 nt lds
    s_add_u32 s49, s49, 32768
    s_and_b32 s49, s49, 0x7ffff
L_ptd_22:
    v_max3_f32 v228, v112, v113, v114
    v_max3_f32 v228, v228, v115, v116
    v_max3_f32 v228, v228, v117, v118
    v_max3_f32 v228, v228, v119, v120
    v_max3_f32 v228, v228, v121, v122
    v_max3_f32 v228, v228, v123, v124
    v_max3_f32 v228, v228, v125, v126
    v_max_f32 v228, v228, v127
    v_mov_b32 v229, v228
    s_nop 1
    v_permlane32_swap_b32 v228, v229
    s_nop 1
    v_max3_f32 v228, v228, v229, v226
    v_sub_f32 v231, v226, v228
    v_mul_f32 v231, s55, v231
    v_exp_f32 v231, v231
    v_mul_f32 v232, s55, v228
    v_mov_b32 v226, v228
    v_fma_f32 v112, v112, s55, -v232
    v_fma_f32 v113, v113, s55, -v232
    v_fma_f32 v114, v114, s55, -v232
    v_fma_f32 v115, v115, s55, -v232
    v_fma_f32 v116, v116, s55, -v232
    v_fma_f32 v117, v117, s55, -v232
    v_fma_f32 v118, v118, s55, -v232
    v_fma_f32 v119, v119, s55, -v232
    v_fma_f32 v120, v120, s55, -v232
    v_fma_f32 v121, v121, s55, -v232
    v_fma_f32 v122, v122, s55, -v232
    v_fma_f32 v123, v123, s55, -v232
    v_fma_f32 v124, v124, s55, -v232
    v_fma_f32 v125, v125, s55, -v232
    v_fma_f32 v126, v126, s55, -v232
    v_fma_f32 v127, v127, s55, -v232
    v_exp_f32 v112, v112
    v_exp_f32 v113, v113
    v_exp_f32 v114, v114
    v_exp_f32 v115, v115
    v_exp_f32 v116, v116
    v_exp_f32 v117, v117
    v_exp_f32 v118, v118
    v_exp_f32 v119, v119
    v_exp_f32 v120, v120
    v_exp_f32 v121, v121
    v_exp_f32 v122, v122
    v_exp_f32 v123, v123
    v_exp_f32 v124, v124
    v_exp_f32 v125, v125
    v_exp_f32 v126, v126
    v_exp_f32 v127, v127
    v_mul_f32 v227, v227, v231
    v_mul_f32 v48, v48, v231
    v_mul_f32 v49, v49, v231
    v_mul_f32 v50, v50, v231
    v_mul_f32 v51, v51, v231
    v_mul_f32 v52, v52, v231
    v_mul_f32 v53, v53, v231
    v_mul_f32 v54, v54, v231
    v_mul_f32 v55, v55, v231
    v_mul_f32 v56, v56, v231
    v_mul_f32 v57, v57, v231
    v_mul_f32 v58, v58, v231
    v_mul_f32 v59, v59, v231
    v_mul_f32 v60, v60, v231
    v_mul_f32 v61, v61, v231
    v_mul_f32 v62, v62, v231
    v_mul_f32 v63, v63, v231
    v_mul_f32 v64, v64, v231
    v_mul_f32 v65, v65, v231
    v_mul_f32 v66, v66, v231
    v_mul_f32 v67, v67, v231
    v_mul_f32 v68, v68, v231
    v_mul_f32 v69, v69, v231
    v_mul_f32 v70, v70, v231
    v_mul_f32 v71, v71, v231
    v_mul_f32 v72, v72, v231
    v_mul_f32 v73, v73, v231
    v_mul_f32 v74, v74, v231
    v_mul_f32 v75, v75, v231
    v_mul_f32 v76, v76, v231
    v_mul_f32 v77, v77, v231
    v_mul_f32 v78, v78, v231
    v_mul_f32 v79, v79, v231
    v_mul_f32 v80, v80, v231
    v_mul_f32 v81, v81, v231
    v_mul_f32 v82, v82, v231
    v_mul_f32 v83, v83, v231
    v_mul_f32 v84, v84, v231
    v_mul_f32 v85, v85, v231
    v_mul_f32 v86, v86, v231
    v_mul_f32 v87, v87, v231
    v_mul_f32 v88, v88, v231
    v_mul_f32 v89, v89, v231
    v_mul_f32 v90, v90, v231
    v_mul_f32 v91, v91, v231
    v_mul_f32 v92, v92, v231
    v_mul_f32 v93, v93, v231
    v_mul_f32 v94, v94, v231
    v_mul_f32 v95, v95, v231
    v_mul_f32 v96, v96, v231
    v_mul_f32 v97, v97, v231
    v_mul_f32 v98, v98, v231
    v_mul_f32 v99, v99, v231
    v_mul_f32 v100, v100, v231
    v_mul_f32 v101, v101, v231
    v_mul_f32 v102, v102, v231
    v_mul_f32 v103, v103, v231
    v_mul_f32 v104, v104, v231
    v_mul_f32 v105, v105, v231
    v_mul_f32 v106, v106, v231
    v_mul_f32 v107, v107, v231
    v_mul_f32 v108, v108, v231
    v_mul_f32 v109, v109, v231
    v_mul_f32 v110, v110, v231
    v_mul_f32 v111, v111, v231
    v_add_f32 v227, v227, v112
    v_add_f32 v227, v227, v113
    v_add_f32 v227, v227, v114
    v_add_f32 v227, v227, v115
    v_add_f32 v227, v227, v116
    v_add_f32 v227, v227, v117
    v_add_f32 v227, v227, v118
    v_add_f32 v227, v227, v119
    v_add_f32 v227, v227, v120
    v_add_f32 v227, v227, v121
    v_add_f32 v227, v227, v122
    v_add_f32 v227, v227, v123
    v_add_f32 v227, v227, v124
    v_add_f32 v227, v227, v125
    v_add_f32 v227, v227, v126
    v_add_f32 v227, v227, v127
    v_cvt_pk_bf16_f32 v192, v112, v113
    v_cvt_pk_bf16_f32 v193, v114, v115
    v_cvt_pk_bf16_f32 v194, v116, v117
    v_cvt_pk_bf16_f32 v195, v118, v119
    v_cvt_pk_bf16_f32 v196, v120, v121
    v_cvt_pk_bf16_f32 v197, v122, v123
    v_cvt_pk_bf16_f32 v198, v124, v125
    v_cvt_pk_bf16_f32 v199, v126, v127
    s_waitcnt vmcnt(24)
    ds_read_b64_tr_b16 v[160:161], v212 offset:24576
    ds_read_b64_tr_b16 v[162:163], v213 offset:26624
    ds_read_b64_tr_b16 v[164:165], v212 offset:28672
    ds_read_b64_tr_b16 v[166:167], v213 offset:30720
    ds_read_b64_tr_b16 v[168:169], v214 offset:24576
    ds_read_b64_tr_b16 v[170:171], v215 offset:26624
    ds_read_b64_tr_b16 v[172:173], v214 offset:28672
    ds_read_b64_tr_b16 v[174:175], v215 offset:30720
    ds_read_b64_tr_b16 v[176:177], v216 offset:24576
    ds_read_b64_tr_b16 v[178:179], v217 offset:26624
    ds_read_b64_tr_b16 v[180:181], v216 offset:28672
    ds_read_b64_tr_b16 v[182:183], v217 offset:30720
    ds_read_b64_tr_b16 v[184:185], v218 offset:24576
    ds_read_b64_tr_b16 v[186:187], v219 offset:26624
    ds_read_b64_tr_b16 v[188:189], v218 offset:28672
    ds_read_b64_tr_b16 v[190:191], v219 offset:30720
    s_waitcnt lgkmcnt(14)
    v_mfma_f32_32x32x16_bf16 v[48:63], v[160:163], v[192:195], v[48:63]
    s_waitcnt lgkmcnt(12)
    v_mfma_f32_32x32x16_bf16 v[48:63], v[164:167], v[196:199], v[48:63]
    s_waitcnt lgkmcnt(10)
    v_mfma_f32_32x32x16_bf16 v[64:79], v[168:171], v[192:195], v[64:79]
    s_waitcnt lgkmcnt(8)
    v_mfma_f32_32x32x16_bf16 v[64:79], v[172:175], v[196:199], v[64:79]
    s_waitcnt lgkmcnt(6)
    v_mfma_f32_32x32x16_bf16 v[80:95], v[176:179], v[192:195], v[80:95]
    s_waitcnt lgkmcnt(4)
    v_mfma_f32_32x32x16_bf16 v[80:95], v[180:183], v[196:199], v[80:95]
    s_waitcnt lgkmcnt(2)
    v_mfma_f32_32x32x16_bf16 v[96:111], v[184:187], v[192:195], v[96:111]
    s_waitcnt lgkmcnt(0)
    v_mfma_f32_32x32x16_bf16 v[96:111], v[188:191], v[196:199], v[96:111]
    s_cmp_eq_u32 s59, 1
    s_cbranch_scc1 L_pt1_32
    s_cmp_eq_u32 s59, 2
    s_cbranch_scc1 L_pt5_33
    s_cmp_eq_u32 s59, 3
    s_cbranch_scc1 L_pt9_34
    s_cmp_eq_u32 s59, 4
    s_cbranch_scc1 L_pt13_35
    s_cmp_eq_u32 s59, 5
    s_cbranch_scc1 L_pt17_36
    s_waitcnt vmcnt(8)
    s_add_u32 m0, s48, 24576
    s_nop 0
    buffer_load_dwordx4 v200, s[24:27], s50 offen offset:0 nt lds
    buffer_load_dwordx4 v201, s[24:27], s50 offen offset:1024 nt lds
    buffer_load_dwordx4 v202, s[24:27], s50 offen offset:2048 nt lds
    buffer_load_dwordx4 v203, s[24:27], s50 offen offset:3072 nt lds
    s_waitcnt vmcnt(8)
    s_add_u32 m0, s48, 28672
    s_add_u32 s63, s50, 4096
    buffer_load_dwordx4 v200, s[24:27], s63 offen offset:0 nt lds
    buffer_load_dwordx4 v201, s[24:27], s63 offen offset:1024 nt lds
    buffer_load_dwordx4 v202, s[24:27], s63 offen offset:2048 nt lds
    buffer_load_dwordx4 v203, s[24:27], s63 offen offset:3072 nt lds
    s_add_u32 s50, s50, 32768
    s_and_b32 s50, s50, 0x7ffff
    s_branch L_ptd_31
L_pt1_32:
    s_add_u32 m0, s48, 36864
    s_nop 0
    buffer_load_dwordx4 v241, s[36:39], s51 offen sc1 lds
    s_add_u32 s51, s51, s94
    s_add_u32 m0, s48, 37888
    s_nop 0
    buffer_load_dwordx4 v241, s[36:39], s51 offen sc1 lds
    s_add_u32 s51, s51, s94
    s_add_u32 m0, s48, 38912
    s_nop 0
    buffer_load_dwordx4 v241, s[36:39], s51 offen sc1 lds
    s_add_u32 s51, s51, s94
    s_add_u32 m0, s48, 39936
    s_nop 0
    buffer_load_dwordx4 v241, s[36:39], s51 offen sc1 lds
    s_add_u32 s51, s51, s94
    s_branch L_ptkv_37
L_pt5_33:
    s_waitcnt vmcnt(20)
    ds_read_b64_tr_b16 a[48:49], v242 offset:36864
    ds_read_b64_tr_b16 a[50:51], v242 offset:37120
    ds_read_b64_tr_b16 a[52:53], v243 offset:36864
    ds_read_b64_tr_b16 a[54:55], v243 offset:37120
    ds_read_b64_tr_b16 a[56:57], v242 offset:38912
    ds_read_b64_tr_b16 a[58:59], v242 offset:39168
    ds_read_b64_tr_b16 a[60:61], v243 offset:38912
    ds_read_b64_tr_b16 a[62:63], v243 offset:39168
    s_waitcnt lgkmcnt(0)
    s_add_u32 m0, s48, 36864
    s_nop 0
    buffer_load_dwordx4 v241, s[36:39], s51 offen sc1 lds
    s_add_u32 s51, s51, s94
    s_add_u32 m0, s48, 37888
    s_nop 0
    buffer_load_dwordx4 v241, s[36:39], s51 offen sc1 lds
    s_add_u32 s51, s51, s94
    s_add_u32 m0, s48, 38912
    s_nop 0
    buffer_load_dwordx4 v241, s[36:39], s51 offen sc1 lds
    s_add_u32 s51, s51, s94
    s_add_u32 m0, s48, 39936
    s_nop 0
    buffer_load_dwordx4 v241, s[36:39], s51 offen sc1 lds
    s_add_u32 s51, s51, s94
    s_branch L_ptkv_37
L_pt9_34:
    s_waitcnt vmcnt(20)
    ds_read_b64_tr_b16 a[112:113], v242 offset:36864
    ds_read_b64_tr_b16 a[114:115], v242 offset:37120
    ds_read_b64_tr_b16 a[116:117], v243 offset:36864
    ds_read_b64_tr_b16 a[118:119], v243 offset:37120
    ds_read_b64_tr_b16 a[120:121], v242 offset:38912
    ds_read_b64_tr_b16 a[122:123], v242 offset:39168
    ds_read_b64_tr_b16 a[124:125], v243 offset:38912
    ds_read_b64_tr_b16 a[126:127], v243 offset:39168
    s_waitcnt lgkmcnt(0)
    s_add_u32 m0, s48, 36864
    s_nop 0
    buffer_load_dwordx4 v241, s[36:39], s51 offen sc1 lds
    s_add_u32 s51, s51, s94
    s_add_u32 m0, s48, 37888
    s_nop 0
    buffer_load_dwordx4 v241, s[36:39], s51 offen sc1 lds
    s_add_u32 s51, s51, s94
    s_add_u32 m0, s48, 38912
    s_nop 0
    buffer_load_dwordx4 v241, s[36:39], s51 offen sc1 lds
    s_add_u32 s51, s51, s94
    s_add_u32 m0, s48, 39936
    s_nop 0
    buffer_load_dwordx4 v241, s[36:39], s51 offen sc1 lds
    s_add_u32 s51, s51, s94
    s_branch L_ptkv_37
L_pt13_35:
    s_waitcnt vmcnt(20)
    ds_read_b64_tr_b16 a[176:177], v242 offset:36864
    ds_read_b64_tr_b16 a[178:179], v242 offset:37120
    ds_read_b64_tr_b16 a[180:181], v243 offset:36864
    ds_read_b64_tr_b16 a[182:183], v243 offset:37120
    ds_read_b64_tr_b16 a[184:185], v242 offset:38912
    ds_read_b64_tr_b16 a[186:187], v242 offset:39168
    ds_read_b64_tr_b16 a[188:189], v243 offset:38912
    ds_read_b64_tr_b16 a[190:191], v243 offset:39168
    s_waitcnt lgkmcnt(0)
    s_add_u32 m0, s48, 36864
    s_nop 0
    buffer_load_dwordx4 v241, s[36:39], s51 offen sc1 lds
    s_add_u32 s51, s51, s94
    s_add_u32 m0, s48, 37888
    s_nop 0
    buffer_load_dwordx4 v241, s[36:39], s51 offen sc1 lds
    s_add_u32 s51, s51, s94
    s_add_u32 m0, s48, 38912
    s_nop 0
    buffer_load_dwordx4 v241, s[36:39], s51 offen sc1 lds
    s_add_u32 s51, s51, s94
    s_add_u32 m0, s48, 39936
    s_nop 0
    buffer_load_dwordx4 v241, s[36:39], s51 offen sc1 lds
    s_add_u32 s51, s51, s94
    s_branch L_ptkv_37
L_pt17_36:
    s_waitcnt vmcnt(16)
    ds_read_b64_tr_b16 a[240:241], v242 offset:36864
    ds_read_b64_tr_b16 a[242:243], v242 offset:37120
    ds_read_b64_tr_b16 a[244:245], v243 offset:36864
    ds_read_b64_tr_b16 a[246:247], v243 offset:37120
    ds_read_b64_tr_b16 a[248:249], v242 offset:38912
    ds_read_b64_tr_b16 a[250:251], v242 offset:39168
    ds_read_b64_tr_b16 a[252:253], v243 offset:38912
    ds_read_b64_tr_b16 a[254:255], v243 offset:39168
    s_waitcnt lgkmcnt(0)
L_ptkv_37:
    s_add_u32 m0, s48, 24576
    s_nop 0
    buffer_load_dwordx4 v200, s[24:27], s50 offen offset:0 nt lds
    buffer_load_dwordx4 v201, s[24:27], s50 offen offset:1024 nt lds
    buffer_load_dwordx4 v202, s[24:27], s50 offen offset:2048 nt lds
    buffer_load_dwordx4 v203, s[24:27], s50 offen offset:3072 nt lds
    s_add_u32 m0, s48, 28672
    s_add_u32 s63, s50, 4096
    buffer_load_dwordx4 v200, s[24:27], s63 offen offset:0 nt lds
    buffer_load_dwordx4 v201, s[24:27], s63 offen offset:1024 nt lds
    buffer_load_dwordx4 v202, s[24:27], s63 offen offset:2048 nt lds
    buffer_load_dwordx4 v203, s[24:27], s63 offen offset:3072 nt lds
    s_add_u32 s50, s50, 32768
    s_and_b32 s50, s50, 0x7ffff
L_ptd_31:
    s_cmp_lg_u32 s59, 0
    s_cbranch_scc1 L_t1_38
    v_mfma_f32_32x32x16_bf16 v[112:127], a[192:195], v[16:19], 0
    v_mfma_f32_32x32x16_bf16 v[112:127], a[196:199], v[20:23], v[112:127]
    v_mfma_f32_32x32x16_bf16 v[112:127], a[200:203], v[24:27], v[112:127]
    v_mfma_f32_32x32x16_bf16 v[112:127], a[204:207], v[28:31], v[112:127]
    v_mfma_f32_32x32x16_bf16 v[112:127], a[208:211], v[32:35], v[112:127]
    v_mfma_f32_32x32x16_bf16 v[112:127], a[212:215], v[36:39], v[112:127]
    v_mfma_f32_32x32x16_bf16 v[112:127], a[216:219], v[40:43], v[112:127]
    v_mfma_f32_32x32x16_bf16 v[112:127], a[220:223], v[44:47], v[112:127]
    s_nop 7
    s_nop 3
    v_max3_f32 v228, v112, v113, v114
    v_max3_f32 v228, v228, v115, v116
    v_max3_f32 v228, v228, v117, v118
    v_max3_f32 v228, v228, v119, v120
    v_max3_f32 v228, v228, v121, v122
    v_max3_f32 v228, v228, v123, v124
    v_max3_f32 v228, v228, v125, v126
    v_max_f32 v228, v228, v127
    v_mov_b32 v229, v228
    s_nop 1
    v_permlane32_swap_b32 v228, v229
    s_nop 1
    v_max3_f32 v228, v228, v229, v226
    v_sub_f32 v231, v226, v228
    v_mul_f32 v231, s55, v231
    v_exp_f32 v231, v231
    v_mul_f32 v232, s55, v228
    v_mov_b32 v226, v228
    v_fma_f32 v112, v112, s55, -v232
    v_fma_f32 v113, v113, s55, -v232
    v_fma_f32 v114, v114, s55, -v232
    v_fma_f32 v115, v115, s55, -v232
    v_fma_f32 v116, v116, s55, -v232
    v_fma_f32 v117, v117, s55, -v232
    v_fma_f32 v118, v118, s55, -v232
    v_fma_f32 v119, v119, s55, -v232
    v_fma_f32 v120, v120, s55, -v232
    v_fma_f32 v121, v121, s55, -v232
    v_fma_f32 v122, v122, s55, -v232
    v_fma_f32 v123, v123, s55, -v232
    v_fma_f32 v124, v124, s55, -v232
    v_fma_f32 v125, v125, s55, -v232
    v_fma_f32 v126, v126, s55, -v232
    v_fma_f32 v127, v127, s55, -v232
    v_exp_f32 v112, v112
    v_exp_f32 v113, v113
    v_exp_f32 v114, v114
    v_exp_f32 v115, v115
    v_exp_f32 v116, v116
    v_exp_f32 v117, v117
    v_exp_f32 v118, v118
    v_exp_f32 v119, v119
    v_exp_f32 v120, v120
    v_exp_f32 v121, v121
    v_exp_f32 v122, v122
    v_exp_f32 v123, v123
    v_exp_f32 v124, v124
    v_exp_f32 v125, v125
    v_exp_f32 v126, v126
    v_exp_f32 v127, v127
    v_mul_f32 v227, v227, v231
    v_mul_f32 v48, v48, v231
    v_mul_f32 v49, v49, v231
    v_mul_f32 v50, v50, v231
    v_mul_f32 v51, v51, v231
    v_mul_f32 v52, v52, v231
    v_mul_f32 v53, v53, v231
    v_mul_f32 v54, v54, v231
    v_mul_f32 v55, v55, v231
    v_mul_f32 v56, v56, v231
    v_mul_f32 v57, v57, v231
    v_mul_f32 v58, v58, v231
    v_mul_f32 v59, v59, v231
    v_mul_f32 v60, v60, v231
    v_mul_f32 v61, v61, v231
    v_mul_f32 v62, v62, v231
    v_mul_f32 v63, v63, v231
    v_mul_f32 v64, v64, v231
    v_mul_f32 v65, v65, v231
    v_mul_f32 v66, v66, v231
    v_mul_f32 v67, v67, v231
    v_mul_f32 v68, v68, v231
    v_mul_f32 v69, v69, v231
    v_mul_f32 v70, v70, v231
    v_mul_f32 v71, v71, v231
    v_mul_f32 v72, v72, v231
    v_mul_f32 v73, v73, v231
    v_mul_f32 v74, v74, v231
    v_mul_f32 v75, v75, v231
    v_mul_f32 v76, v76, v231
    v_mul_f32 v77, v77, v231
    v_mul_f32 v78, v78, v231
    v_mul_f32 v79, v79, v231
    v_mul_f32 v80, v80, v231
    v_mul_f32 v81, v81, v231
    v_mul_f32 v82, v82, v231
    v_mul_f32 v83, v83, v231
    v_mul_f32 v84, v84, v231
    v_mul_f32 v85, v85, v231
    v_mul_f32 v86, v86, v231
    v_mul_f32 v87, v87, v231
    v_mul_f32 v88, v88, v231
    v_mul_f32 v89, v89, v231
    v_mul_f32 v90, v90, v231
    v_mul_f32 v91, v91, v231
    v_mul_f32 v92, v92, v231
    v_mul_f32 v93, v93, v231
    v_mul_f32 v94, v94, v231
    v_mul_f32 v95, v95, v231
    v_mul_f32 v96, v96, v231
    v_mul_f32 v97, v97, v231
    v_mul_f32 v98, v98, v231
    v_mul_f32 v99, v99, v231
    v_mul_f32 v100, v100, v231
    v_mul_f32 v101, v101, v231
    v_mul_f32 v102, v102, v231
    v_mul_f32 v103, v103, v231
    v_mul_f32 v104, v104, v231
    v_mul_f32 v105, v105, v231
    v_mul_f32 v106, v106, v231
    v_mul_f32 v107, v107, v231
    v_mul_f32 v108, v108, v231
    v_mul_f32 v109, v109, v231
    v_mul_f32 v110, v110, v231
    v_mul_f32 v111, v111, v231
    v_add_f32 v227, v227, v112
    v_add_f32 v227, v227, v113
    v_add_f32 v227, v227, v114
    v_add_f32 v227, v227, v115
    v_add_f32 v227, v227, v116
    v_add_f32 v227, v227, v117
    v_add_f32 v227, v227, v118
    v_add_f32 v227, v227, v119
    v_add_f32 v227, v227, v120
    v_add_f32 v227, v227, v121
    v_add_f32 v227, v227, v122
    v_add_f32 v227, v227, v123
    v_add_f32 v227, v227, v124
    v_add_f32 v227, v227, v125
    v_add_f32 v227, v227, v126
    v_add_f32 v227, v227, v127
    v_cvt_pk_bf16_f32 v192, v112, v113
    v_cvt_pk_bf16_f32 v193, v114, v115
    v_cvt_pk_bf16_f32 v194, v116, v117
    v_cvt_pk_bf16_f32 v195, v118, v119
    v_cvt_pk_bf16_f32 v196, v120, v121
    v_cvt_pk_bf16_f32 v197, v122, v123
    v_cvt_pk_bf16_f32 v198, v124, v125
    v_cvt_pk_bf16_f32 v199, v126, v127
    s_nop 1
    v_mfma_f32_32x32x16_bf16 v[48:63], a[224:227], v[192:195], v[48:63]
    v_mfma_f32_32x32x16_bf16 v[48:63], a[228:231], v[196:199], v[48:63]
    v_mfma_f32_32x32x16_bf16 v[64:79], a[232:235], v[192:195], v[64:79]
    v_mfma_f32_32x32x16_bf16 v[64:79], a[236:239], v[196:199], v[64:79]
    v_mfma_f32_32x32x16_bf16 v[80:95], a[240:243], v[192:195], v[80:95]
    v_mfma_f32_32x32x16_bf16 v[80:95], a[244:247], v[196:199], v[80:95]
    v_mfma_f32_32x32x16_bf16 v[96:111], a[248:251], v[192:195], v[96:111]
    v_mfma_f32_32x32x16_bf16 v[96:111], a[252:255], v[196:199], v[96:111]
L_t1_38:
    s_waitcnt vmcnt(24)
    ds_read_b128 v[128:131], v204 offset:8192
    ds_read_b128 v[132:135], v205 offset:8192
    ds_read_b128 v[136:139], v206 offset:8192
    ds_read_b128 v[140:143], v207 offset:8192
    ds_read_b128 v[144:147], v208 offset:8192
    ds_read_b128 v[148:151], v209 offset:8192
    ds_read_b128 v[152:155], v210 offset:8192
    ds_read_b128 v[156:159], v211 offset:8192
    s_waitcnt lgkmcnt(7)
    v_mfma_f32_32x32x16_bf16 v[112:127], v[128:131], v[16:19], 0
    s_waitcnt lgkmcnt(6)
    v_mfma_f32_32x32x16_bf16 v[112:127], v[132:135], v[20:23], v[112:127]
    s_waitcnt lgkmcnt(5)
    v_mfma_f32_32x32x16_bf16 v[112:127], v[136:139], v[24:27], v[112:127]
    s_waitcnt lgkmcnt(4)
    v_mfma_f32_32x32x16_bf16 v[112:127], v[140:143], v[28:31], v[112:127]
    s_waitcnt lgkmcnt(3)
    v_mfma_f32_32x32x16_bf16 v[112:127], v[144:147], v[32:35], v[112:127]
    s_waitcnt lgkmcnt(2)
    v_mfma_f32_32x32x16_bf16 v[112:127], v[148:151], v[36:39], v[112:127]
    s_waitcnt lgkmcnt(1)
    v_mfma_f32_32x32x16_bf16 v[112:127], v[152:155], v[40:43], v[112:127]
    s_waitcnt lgkmcnt(0)
    v_mfma_f32_32x32x16_bf16 v[112:127], v[156:159], v[44:47], v[112:127]
    s_cmp_eq_u32 s59, 1
    s_cbranch_scc1 L_pt2_40
    s_cmp_eq_u32 s59, 2
    s_cbranch_scc1 L_pt6_41
    s_cmp_eq_u32 s59, 3
    s_cbranch_scc1 L_pt10_42
    s_cmp_eq_u32 s59, 4
    s_cbranch_scc1 L_pt14_43
    s_waitcnt vmcnt(8)
    s_add_u32 m0, s48, 8192
    s_nop 0
    buffer_load_dwordx4 v200, s[20:23], s49 offen offset:0 nt lds
    buffer_load_dwordx4 v201, s[20:23], s49 offen offset:1024 nt lds
    buffer_load_dwordx4 v202, s[20:23], s49 offen offset:2048 nt lds
    buffer_load_dwordx4 v203, s[20:23], s49 offen offset:3072 nt lds
    s_waitcnt vmcnt(8)
    s_add_u32 m0, s48, 12288
    s_add_u32 s63, s49, 4096
    buffer_load_dwordx4 v200, s[20:23], s63 offen offset:0 nt lds
    buffer_load_dwordx4 v201, s[20:23], s63 offen offset:1024 nt lds
    buffer_load_dwordx4 v202, s[20:23], s63 offen offset:2048 nt lds
    buffer_load_dwordx4 v203, s[20:23], s63 offen offset:3072 nt lds
    s_add_u32 s49, s49, 32768
    s_and_b32 s49, s49, 0x7ffff
    s_branch L_ptd_39
L_pt2_40:
    s_waitcnt vmcnt(20)
    ds_read_b64_tr_b16 a[0:1], v242 offset:32768
    ds_read_b64_tr_b16 a[2:3], v242 offset:33024
    ds_read_b64_tr_b16 a[4:5], v243 offset:32768
    ds_read_b64_tr_b16 a[6:7], v243 offset:33024
    ds_read_b64_tr_b16 a[8:9], v242 offset:34816
    ds_read_b64_tr_b16 a[10:11], v242 offset:35072
    ds_read_b64_tr_b16 a[12:13], v243 offset:34816
    ds_read_b64_tr_b16 a[14:15], v243 offset:35072
    s_waitcnt lgkmcnt(0)
    s_add_u32 m0, s48, 32768
    s_nop 0
    buffer_load_dwordx4 v241, s[36:39], s51 offen sc1 lds
    s_add_u32 s51, s51, s94
    s_add_u32 m0, s48, 33792
    s_nop 0
    buffer_load_dwordx4 v241, s[36:39], s51 offen sc1 lds
    s_add_u32 s51, s51, s94
    s_add_u32 m0, s48, 34816
    s_nop 0
    buffer_load_dwordx4 v241, s[36:39], s51 offen sc1 lds
    s_add_u32 s51, s51, s94
    s_add_u32 m0, s48, 35840
    s_nop 0
    buffer_load_dwordx4 v241, s[36:39], s51 offen sc1 lds
    s_add_u32 s51, s51, s94
    s_branch L_ptkv_44
L_pt6_41:
    s_waitcnt vmcnt(20)
    ds_read_b64_tr_b16 a[64:65], v242 offset:32768
    ds_read_b64_tr_b16 a[66:67], v242 offset:33024
    ds_read_b64_tr_b16 a[68:69], v243 offset:32768
    ds_read_b64_tr_b16 a[70:71], v243 offset:33024
    ds_read_b64_tr_b16 a[72:73], v242 offset:34816
    ds_read_b64_tr_b16 a[74:75], v242 offset:35072
    ds_read_b64_tr_b16 a[76:77], v243 offset:34816
    ds_read_b64_tr_b16 a[78:79], v243 offset:35072
    s_waitcnt lgkmcnt(0)
    s_add_u32 m0, s48, 32768
    s_nop 0
    buffer_load_dwordx4 v241, s[36:39], s51 offen sc1 lds
    s_add_u32 s51, s51, s94
    s_add_u32 m0, s48, 33792
    s_nop 0
    buffer_load_dwordx4 v241, s[36:39], s51 offen sc1 lds
    s_add_u32 s51, s51, s94
    s_add_u32 m0, s48, 34816
    s_nop 0
    buffer_load_dwordx4 v241, s[36:39], s51 offen sc1 lds
    s_add_u32 s51, s51, s94
    s_add_u32 m0, s48, 35840
    s_nop 0
    buffer_load_dwordx4 v241, s[36:39], s51 offen sc1 lds
    s_add_u32 s51, s51, s94
    s_branch L_ptkv_44
L_pt10_42:
    s_waitcnt vmcnt(20)
    ds_read_b64_tr_b16 a[128:129], v242 offset:32768
    ds_read_b64_tr_b16 a[130:131], v242 offset:33024
    ds_read_b64_tr_b16 a[132:133], v243 offset:32768
    ds_read_b64_tr_b16 a[134:135], v243 offset:33024
    ds_read_b64_tr_b16 a[136:137], v242 offset:34816
    ds_read_b64_tr_b16 a[138:139], v242 offset:35072
    ds_read_b64_tr_b16 a[140:141], v243 offset:34816
    ds_read_b64_tr_b16 a[142:143], v243 offset:35072
    s_waitcnt lgkmcnt(0)
    s_add_u32 m0, s48, 32768
    s_nop 0
    buffer_load_dwordx4 v241, s[36:39], s51 offen sc1 lds
    s_add_u32 s51, s51, s94
    s_add_u32 m0, s48, 33792
    s_nop 0
    buffer_load_dwordx4 v241, s[36:39], s51 offen sc1 lds
    s_add_u32 s51, s51, s94
    s_add_u32 m0, s48, 34816
    s_nop 0
    buffer_load_dwordx4 v241, s[36:39], s51 offen sc1 lds
    s_add_u32 s51, s51, s94
    s_add_u32 m0, s48, 35840
    s_nop 0
    buffer_load_dwordx4 v241, s[36:39], s51 offen sc1 lds
    s_add_u32 s51, s51, s94
    s_branch L_ptkv_44
L_pt14_43:
    s_waitcnt vmcnt(20)
    ds_read_b64_tr_b16 a[192:193], v242 offset:32768
    ds_read_b64_tr_b16 a[194:195], v242 offset:33024
    ds_read_b64_tr_b16 a[196:197], v243 offset:32768
    ds_read_b64_tr_b16 a[198:199], v243 offset:33024
    ds_read_b64_tr_b16 a[200:201], v242 offset:34816
    ds_read_b64_tr_b16 a[202:203], v242 offset:35072
    ds_read_b64_tr_b16 a[204:205], v243 offset:34816
    ds_read_b64_tr_b16 a[206:207], v243 offset:35072
    s_waitcnt lgkmcnt(0)
    s_add_u32 m0, s48, 32768
    s_nop 0
    buffer_load_dwordx4 v241, s[36:39], s51 offen sc1 lds
    s_add_u32 s51, s51, s94
    s_add_u32 m0, s48, 33792
    s_nop 0
    buffer_load_dwordx4 v241, s[36:39], s51 offen sc1 lds
    s_add_u32 s51, s51, s94
    s_add_u32 m0, s48, 34816
    s_nop 0
    buffer_load_dwordx4 v241, s[36:39], s51 offen sc1 lds
    s_add_u32 s51, s51, s94
    s_add_u32 m0, s48, 35840
    s_nop 0
    buffer_load_dwordx4 v241, s[36:39], s51 offen sc1 lds
    s_add_u32 s51, s51, s94
L_ptkv_44:
    s_add_u32 m0, s48, 8192
    s_nop 0
    buffer_load_dwordx4 v200, s[20:23], s49 offen offset:0 nt lds
    buffer_load_dwordx4 v201, s[20:23], s49 offen offset:1024 nt lds
    buffer_load_dwordx4 v202, s[20:23], s49 offen offset:2048 nt lds
    buffer_load_dwordx4 v203, s[20:23], s49 offen offset:3072 nt lds
    s_add_u32 m0, s48, 12288
    s_add_u32 s63, s49, 4096
    buffer_load_dwordx4 v200, s[20:23], s63 offen offset:0 nt lds
    buffer_load_dwordx4 v201, s[20:23], s63 offen offset:1024 nt lds
    buffer_load_dwordx4 v202, s[20:23], s63 offen offset:2048 nt lds
    buffer_load_dwordx4 v203, s[20:23], s63 offen offset:3072 nt lds
    s_add_u32 s49, s49, 32768
    s_and_b32 s49, s49, 0x7ffff
L_ptd_39:
    v_max3_f32 v228, v112, v113, v114
    v_max3_f32 v228, v228, v115, v116
    v_max3_f32 v228, v228, v117, v118
    v_max3_f32 v228, v228, v119, v120
    v_max3_f32 v228, v228, v121, v122
    v_max3_f32 v228, v228, v123, v124
    v_max3_f32 v228, v228, v125, v126
    v_max_f32 v228, v228, v127
    v_mov_b32 v229, v228
    s_nop 1
    v_permlane32_swap_b32 v228, v229
    s_nop 1
    v_max3_f32 v228, v228, v229, v226
    v_sub_f32 v231, v226, v228
    v_mul_f32 v231, s55, v231
    v_exp_f32 v231, v231
    v_mul_f32 v232, s55, v228
    v_mov_b32 v226, v228
    v_fma_f32 v112, v112, s55, -v232
    v_fma_f32 v113, v113, s55, -v232
    v_fma_f32 v114, v114, s55, -v232
    v_fma_f32 v115, v115, s55, -v232
    v_fma_f32 v116, v116, s55, -v232
    v_fma_f32 v117, v117, s55, -v232
    v_fma_f32 v118, v118, s55, -v232
    v_fma_f32 v119, v119, s55, -v232
    v_fma_f32 v120, v120, s55, -v232
    v_fma_f32 v121, v121, s55, -v232
    v_fma_f32 v122, v122, s55, -v232
    v_fma_f32 v123, v123, s55, -v232
    v_fma_f32 v124, v124, s55, -v232
    v_fma_f32 v125, v125, s55, -v232
    v_fma_f32 v126, v126, s55, -v232
    v_fma_f32 v127, v127, s55, -v232
    v_exp_f32 v112, v112
    v_exp_f32 v113, v113
    v_exp_f32 v114, v114
    v_exp_f32 v115, v115
    v_exp_f32 v116, v116
    v_exp_f32 v117, v117
    v_exp_f32 v118, v118
    v_exp_f32 v119, v119
    v_exp_f32 v120, v120
    v_exp_f32 v121, v121
    v_exp_f32 v122, v122
    v_exp_f32 v123, v123
    v_exp_f32 v124, v124
    v_exp_f32 v125, v125
    v_exp_f32 v126, v126
    v_exp_f32 v127, v127
    v_mul_f32 v227, v227, v231
    v_mul_f32 v48, v48, v231
    v_mul_f32 v49, v49, v231
    v_mul_f32 v50, v50, v231
    v_mul_f32 v51, v51, v231
    v_mul_f32 v52, v52, v231
    v_mul_f32 v53, v53, v231
    v_mul_f32 v54, v54, v231
    v_mul_f32 v55, v55, v231
    v_mul_f32 v56, v56, v231
    v_mul_f32 v57, v57, v231
    v_mul_f32 v58, v58, v231
    v_mul_f32 v59, v59, v231
    v_mul_f32 v60, v60, v231
    v_mul_f32 v61, v61, v231
    v_mul_f32 v62, v62, v231
    v_mul_f32 v63, v63, v231
    v_mul_f32 v64, v64, v231
    v_mul_f32 v65, v65, v231
    v_mul_f32 v66, v66, v231
    v_mul_f32 v67, v67, v231
    v_mul_f32 v68, v68, v231
    v_mul_f32 v69, v69, v231
    v_mul_f32 v70, v70, v231
    v_mul_f32 v71, v71, v231
    v_mul_f32 v72, v72, v231
    v_mul_f32 v73, v73, v231
    v_mul_f32 v74, v74, v231
    v_mul_f32 v75, v75, v231
    v_mul_f32 v76, v76, v231
    v_mul_f32 v77, v77, v231
    v_mul_f32 v78, v78, v231
    v_mul_f32 v79, v79, v231
    v_mul_f32 v80, v80, v231
    v_mul_f32 v81, v81, v231
    v_mul_f32 v82, v82, v231
    v_mul_f32 v83, v83, v231
    v_mul_f32 v84, v84, v231
    v_mul_f32 v85, v85, v231
    v_mul_f32 v86, v86, v231
    v_mul_f32 v87, v87, v231
    v_mul_f32 v88, v88, v231
    v_mul_f32 v89, v89, v231
    v_mul_f32 v90, v90, v231
    v_mul_f32 v91, v91, v231
    v_mul_f32 v92, v92, v231
    v_mul_f32 v93, v93, v231
    v_mul_f32 v94, v94, v231
    v_mul_f32 v95, v95, v231
    v_mul_f32 v96, v96, v231
    v_mul_f32 v97, v97, v231
    v_mul_f32 v98, v98, v231
    v_mul_f32 v99, v99, v231
    v_mul_f32 v100, v100, v231
    v_mul_f32 v101, v101, v231
    v_mul_f32 v102, v102, v231
    v_mul_f32 v103, v103, v231
    v_mul_f32 v104, v104, v231
    v_mul_f32 v105, v105, v231
    v_mul_f32 v106, v106, v231
    v_mul_f32 v107, v107, v231
    v_mul_f32 v108, v108, v231
    v_mul_f32 v109, v109, v231
    v_mul_f32 v110, v110, v231
    v_mul_f32 v111, v111, v231
    v_add_f32 v227, v227, v112
    v_add_f32 v227, v227, v113
    v_add_f32 v227, v227, v114
    v_add_f32 v227, v227, v115
    v_add_f32 v227, v227, v116
    v_add_f32 v227, v227, v117
    v_add_f32 v227, v227, v118
    v_add_f32 v227, v227, v119
    v_add_f32 v227, v227, v120
    v_add_f32 v227, v227, v121
    v_add_f32 v227, v227, v122
    v_add_f32 v227, v227, v123
    v_add_f32 v227, v227, v124
    v_add_f32 v227, v227, v125
    v_add_f32 v227, v227, v126
    v_add_f32 v227, v227, v127
    v_cvt_pk_bf16_f32 v192, v112, v113
    v_cvt_pk_bf16_f32 v193, v114, v115
    v_cvt_pk_bf16_f32 v194, v116, v117
    v_cvt_pk_bf16_f32 v195, v118, v119
    v_cvt_pk_bf16_f32 v196, v120, v121
    v_cvt_pk_bf16_f32 v197, v122, v123
    v_cvt_pk_bf16_f32 v198, v124, v125
    v_cvt_pk_bf16_f32 v199, v126, v127
    s_waitcnt vmcnt(24)
    ds_read_b64_tr_b16 v[160:161], v212 offset:16384
    ds_read_b64_tr_b16 v[162:163], v213 offset:18432
    ds_read_b64_tr_b16 v[164:165], v212 offset:20480
    ds_read_b64_tr_b16 v[166:167], v213 offset:22528
    ds_read_b64_tr_b16 v[168:169], v214 offset:16384
    ds_read_b64_tr_b16 v[170:171], v215 offset:18432
    ds_read_b64_tr_b16 v[172:173], v214 offset:20480
    ds_read_b64_tr_b16 v[174:175], v215 offset:22528
    ds_read_b64_tr_b16 v[176:177], v216 offset:16384
    ds_read_b64_tr_b16 v[178:179], v217 offset:18432
    ds_read_b64_tr_b16 v[180:181], v216 offset:20480
    ds_read_b64_tr_b16 v[182:183], v217 offset:22528
    ds_read_b64_tr_b16 v[184:185], v218 offset:16384
    ds_read_b64_tr_b16 v[186:187], v219 offset:18432
    ds_read_b64_tr_b16 v[188:189], v218 offset:20480
    ds_read_b64_tr_b16 v[190:191], v219 offset:22528
    s_waitcnt lgkmcnt(14)
    v_mfma_f32_32x32x16_bf16 v[48:63], v[160:163], v[192:195], v[48:63]
    s_waitcnt lgkmcnt(12)
    v_mfma_f32_32x32x16_bf16 v[48:63], v[164:167], v[196:199], v[48:63]
    s_waitcnt lgkmcnt(10)
    v_mfma_f32_32x32x16_bf16 v[64:79], v[168:171], v[192:195], v[64:79]
    s_waitcnt lgkmcnt(8)
    v_mfma_f32_32x32x16_bf16 v[64:79], v[172:175], v[196:199], v[64:79]
    s_waitcnt lgkmcnt(6)
    v_mfma_f32_32x32x16_bf16 v[80:95], v[176:179], v[192:195], v[80:95]
    s_waitcnt lgkmcnt(4)
    v_mfma_f32_32x32x16_bf16 v[80:95], v[180:183], v[196:199], v[80:95]
    s_waitcnt lgkmcnt(2)
    v_mfma_f32_32x32x16_bf16 v[96:111], v[184:187], v[192:195], v[96:111]
    s_waitcnt lgkmcnt(0)
    v_mfma_f32_32x32x16_bf16 v[96:111], v[188:191], v[196:199], v[96:111]
    s_cmp_eq_u32 s59, 1
    s_cbranch_scc1 L_pt3_46
    s_cmp_eq_u32 s59, 2
    s_cbranch_scc1 L_pt7_47
    s_cmp_eq_u32 s59, 3
    s_cbranch_scc1 L_pt11_48
    s_cmp_eq_u32 s59, 4
    s_cbranch_scc1 L_pt15_49
    s_waitcnt vmcnt(8)
    s_add_u32 m0, s48, 16384
    s_nop 0
    buffer_load_dwordx4 v200, s[24:27], s50 offen offset:0 nt lds
    buffer_load_dwordx4 v201, s[24:27], s50 offen offset:1024 nt lds
    buffer_load_dwordx4 v202, s[24:27], s50 offen offset:2048 nt lds
    buffer_load_dwordx4 v203, s[24:27], s50 offen offset:3072 nt lds
    s_waitcnt vmcnt(8)
    s_add_u32 m0, s48, 20480
    s_add_u32 s63, s50, 4096
    buffer_load_dwordx4 v200, s[24:27], s63 offen offset:0 nt lds
    buffer_load_dwordx4 v201, s[24:27], s63 offen offset:1024 nt lds
    buffer_load_dwordx4 v202, s[24:27], s63 offen offset:2048 nt lds
    buffer_load_dwordx4 v203, s[24:27], s63 offen offset:3072 nt lds
    s_add_u32 s50, s50, 32768
    s_and_b32 s50, s50, 0x7ffff
    s_branch L_ptd_45
L_pt3_46:
    s_waitcnt vmcnt(20)
    ds_read_b64_tr_b16 a[16:17], v242 offset:36864
    ds_read_b64_tr_b16 a[18:19], v242 offset:37120
    ds_read_b64_tr_b16 a[20:21], v243 offset:36864
    ds_read_b64_tr_b16 a[22:23], v243 offset:37120
    ds_read_b64_tr_b16 a[24:25], v242 offset:38912
    ds_read_b64_tr_b16 a[26:27], v242 offset:39168
    ds_read_b64_tr_b16 a[28:29], v243 offset:38912
    ds_read_b64_tr_b16 a[30:31], v243 offset:39168
    s_waitcnt lgkmcnt(0)
    s_add_u32 m0, s48, 36864
    s_nop 0
    buffer_load_dwordx4 v241, s[36:39], s51 offen sc1 lds
    s_add_u32 s51, s51, s94
    s_add_u32 m0, s48, 37888
    s_nop 0
    buffer_load_dwordx4 v241, s[36:39], s51 offen sc1 lds
    s_add_u32 s51, s51, s94
    s_add_u32 m0, s48, 38912
    s_nop 0
    buffer_load_dwordx4 v241, s[36:39], s51 offen sc1 lds
    s_add_u32 s51, s51, s94
    s_add_u32 m0, s48, 39936
    s_nop 0
    buffer_load_dwordx4 v241, s[36:39], s51 offen sc1 lds
    s_add_u32 s51, s51, s94
    s_branch L_ptkv_50
L_pt7_47:
    s_waitcnt vmcnt(20)
    ds_read_b64_tr_b16 a[80:81], v242 offset:36864
    ds_read_b64_tr_b16 a[82:83], v242 offset:37120
    ds_read_b64_tr_b16 a[84:85], v243 offset:36864
    ds_read_b64_tr_b16 a[86:87], v243 offset:37120
    ds_read_b64_tr_b16 a[88:89], v242 offset:38912
    ds_read_b64_tr_b16 a[90:91], v242 offset:39168
    ds_read_b64_tr_b16 a[92:93], v243 offset:38912
    ds_read_b64_tr_b16 a[94:95], v243 offset:39168
    s_waitcnt lgkmcnt(0)
    s_add_u32 m0, s48, 36864
    s_nop 0
    buffer_load_dwordx4 v241, s[36:39], s51 offen sc1 lds
    s_add_u32 s51, s51, s94
    s_add_u32 m0, s48, 37888
    s_nop 0
    buffer_load_dwordx4 v241, s[36:39], s51 offen sc1 lds
    s_add_u32 s51, s51, s94
    s_add_u32 m0, s48, 38912
    s_nop 0
    buffer_load_dwordx4 v241, s[36:39], s51 offen sc1 lds
    s_add_u32 s51, s51, s94
    s_add_u32 m0, s48, 39936
    s_nop 0
    buffer_load_dwordx4 v241, s[36:39], s51 offen sc1 lds
    s_add_u32 s51, s51, s94
    s_branch L_ptkv_50
L_pt11_48:
    s_waitcnt vmcnt(20)
    ds_read_b64_tr_b16 a[144:145], v242 offset:36864
    ds_read_b64_tr_b16 a[146:147], v242 offset:37120
    ds_read_b64_tr_b16 a[148:149], v243 offset:36864
    ds_read_b64_tr_b16 a[150:151], v243 offset:37120
    ds_read_b64_tr_b16 a[152:153], v242 offset:38912
    ds_read_b64_tr_b16 a[154:155], v242 offset:39168
    ds_read_b64_tr_b16 a[156:157], v243 offset:38912
    ds_read_b64_tr_b16 a[158:159], v243 offset:39168
    s_waitcnt lgkmcnt(0)
    s_add_u32 m0, s48, 36864
    s_nop 0
    buffer_load_dwordx4 v241, s[36:39], s51 offen sc1 lds
    s_add_u32 s51, s51, s94
    s_add_u32 m0, s48, 37888
    s_nop 0
    buffer_load_dwordx4 v241, s[36:39], s51 offen sc1 lds
    s_add_u32 s51, s51, s94
    s_add_u32 m0, s48, 38912
    s_nop 0
    buffer_load_dwordx4 v241, s[36:39], s51 offen sc1 lds
    s_add_u32 s51, s51, s94
    s_add_u32 m0, s48, 39936
    s_nop 0
    buffer_load_dwordx4 v241, s[36:39], s51 offen sc1 lds
    s_add_u32 s51, s51, s94
    s_branch L_ptkv_50
L_pt15_49:
    s_waitcnt vmcnt(20)
    ds_read_b64_tr_b16 a[208:209], v242 offset:36864
    ds_read_b64_tr_b16 a[210:211], v242 offset:37120
    ds_read_b64_tr_b16 a[212:213], v243 offset:36864
    ds_read_b64_tr_b16 a[214:215], v243 offset:37120
    ds_read_b64_tr_b16 a[216:217], v242 offset:38912
    ds_read_b64_tr_b16 a[218:219], v242 offset:39168
    ds_read_b64_tr_b16 a[220:221], v243 offset:38912
    ds_read_b64_tr_b16 a[222:223], v243 offset:39168
    s_waitcnt lgkmcnt(0)
    s_add_u32 m0, s48, 36864
    s_nop 0
    buffer_load_dwordx4 v241, s[36:39], s51 offen sc1 lds
    s_add_u32 s51, s51, s94
    s_add_u32 m0, s48, 37888
    s_nop 0
    buffer_load_dwordx4 v241, s[36:39], s51 offen sc1 lds
    s_add_u32 s51, s51, s94
    s_add_u32 m0, s48, 38912
    s_nop 0
    buffer_load_dwordx4 v241, s[36:39], s51 offen sc1 lds
    s_add_u32 s51, s51, s94
    s_add_u32 m0, s48, 39936
    s_nop 0
    buffer_load_dwordx4 v241, s[36:39], s51 offen sc1 lds
    s_add_u32 s51, s51, s94
L_ptkv_50:
    s_add_u32 m0, s48, 16384
    s_nop 0
    buffer_load_dwordx4 v200, s[24:27], s50 offen offset:0 nt lds
    buffer_load_dwordx4 v201, s[24:27], s50 offen offset:1024 nt lds
    buffer_load_dwordx4 v202, s[24:27], s50 offen offset:2048 nt lds
    buffer_load_dwordx4 v203, s[24:27], s50 offen offset:3072 nt lds
    s_add_u32 m0, s48, 20480
    s_add_u32 s63, s50, 4096
    buffer_load_dwordx4 v200, s[24:27], s63 offen offset:0 nt lds
    buffer_load_dwordx4 v201, s[24:27], s63 offen offset:1024 nt lds
    buffer_load_dwordx4 v202, s[24:27], s63 offen offset:2048 nt lds
    buffer_load_dwordx4 v203, s[24:27], s63 offen offset:3072 nt lds
    s_add_u32 s50, s50, 32768
    s_and_b32 s50, s50, 0x7ffff
L_ptd_45:
    s_add_u32 s59, s59, 1
    s_cmp_lt_u32 s59, 6
    s_cbranch_scc1 L_main
    s_lshr_b32 s52, s60, 3
    s_and_b32 s53, s60, 7
    s_lshr_b32 s54, s52, 1
    s_lshl_b32 s54, s54, 7
    s_lshl_b32 s53, s53, 4
    s_add_u32 s54, s54, s53
    s_add_u32 s54, s54, s3
    s_lshl_b32 s54, s54, 10
    s_and_b32 s52, s52, 1
    s_lshl_b32 s52, s52, 7
    s_add_u32 s54, s54, s52
    s_add_u32 s82, s54, 3145728
    v_bfe_u32 v2, v0, 3, 2
    v_lshlrev_b32 v2, 12, v2
    v_and_b32 v10, 7, v0
    v_lshlrev_b32 v10, 4, v10
    v_add_u32 v2, v2, v10
    v_lshrrev_b32 v10, 5, v0
    v_lshlrev_b32 v10, 8, v10
    v_add_u32 v244, v2, v10
    s_lshl_b32 s52, s61, 4
    s_lshl_b32 s53, s3, 1
    s_add_u32 s52, s52, s53
    s_lshl_b32 s52, s52, 7
    s_add_u32 s52, s52, 65536
    v_bfe_u32 v10, v0, 1, 1
    v_lshlrev_b32 v10, 10, v10
    v_and_b32 v11, 1, v0
    v_lshlrev_b32 v11, 7, v11
    v_add_u32 v10, v10, v11
    v_add_u32 v221, s52, v10
    v_add_u32 v246, s48, v240
    v_lshlrev_b32 v4, 3, v0
    v_add_u32 v249, s48, v4
    s_lshl_b32 s52, s3, 12
    v_add_u32 v247, s52, v240
    v_add_u32 v248, 81920, v247
    v_add_u32 v4, 24576, v4
    v_mov_b32 v250, v4
    v_add_u32 v245, 81920, v4
    s_lshl_b32 s52, s60, 7
    s_add_u32 s52, s52, 65536
    v_mov_b32 v251, s52
    v_mov_b32 v252, s56
    s_lshl_b32 s52, s61, 7
    s_lshl_b32 s53, s3, 5
    s_add_u32 s52, s52, s53
    s_lshl_b32 s52, s52, 10
    s_add_u32 s83, s52, 3145728
    s_waitcnt vmcnt(24)
    ds_read_b128 v[128:131], v204 offset:0
    ds_read_b128 v[132:135], v205 offset:0
    ds_read_b128 v[136:139], v206 offset:0
    ds_read_b128 v[140:143], v207 offset:0
    ds_read_b128 v[144:147], v208 offset:0
    ds_read_b128 v[148:151], v209 offset:0
    ds_read_b128 v[152:155], v210 offset:0
    ds_read_b128 v[156:159], v211 offset:0
    s_waitcnt lgkmcnt(7)
    v_mfma_f32_32x32x16_bf16 v[112:127], v[128:131], v[16:19], 0
    s_waitcnt lgkmcnt(6)
    v_mfma_f32_32x32x16_bf16 v[112:127], v[132:135], v[20:23], v[112:127]
    s_waitcnt lgkmcnt(5)
    v_mfma_f32_32x32x16_bf16 v[112:127], v[136:139], v[24:27], v[112:127]
    s_waitcnt lgkmcnt(4)
    v_mfma_f32_32x32x16_bf16 v[112:127], v[140:143], v[28:31], v[112:127]
    s_waitcnt lgkmcnt(3)
    v_mfma_f32_32x32x16_bf16 v[112:127], v[144:147], v[32:35], v[112:127]
    s_waitcnt lgkmcnt(2)
    v_mfma_f32_32x32x16_bf16 v[112:127], v[148:151], v[36:39], v[112:127]
    s_waitcnt lgkmcnt(1)
    v_mfma_f32_32x32x16_bf16 v[112:127], v[152:155], v[40:43], v[112:127]
    s_waitcnt lgkmcnt(0)
    v_mfma_f32_32x32x16_bf16 v[112:127], v[156:159], v[44:47], v[112:127]
    s_nop 7
    s_nop 3
    v_max3_f32 v228, v112, v113, v114
    v_max3_f32 v228, v228, v115, v116
    v_max3_f32 v228, v228, v117, v118
    v_max3_f32 v228, v228, v119, v120
    v_max3_f32 v228, v228, v121, v122
    v_max3_f32 v228, v228, v123, v124
    v_max3_f32 v228, v228, v125, v126
    v_max_f32 v228, v228, v127
    v_mov_b32 v229, v228
    s_nop 1
    v_permlane32_swap_b32 v228, v229
    s_nop 1
    v_max3_f32 v228, v228, v229, v226
    v_sub_f32 v231, v226, v228
    v_mul_f32 v231, s55, v231
    v_exp_f32 v231, v231
    v_mul_f32 v232, s55, v228
    v_mov_b32 v226, v228
    v_fma_f32 v112, v112, s55, -v232
    v_fma_f32 v113, v113, s55, -v232
    v_fma_f32 v114, v114, s55, -v232
    v_fma_f32 v115, v115, s55, -v232
    v_fma_f32 v116, v116, s55, -v232
    v_fma_f32 v117, v117, s55, -v232
    v_fma_f32 v118, v118, s55, -v232
    v_fma_f32 v119, v119, s55, -v232
    v_fma_f32 v120, v120, s55, -v232
    v_fma_f32 v121, v121, s55, -v232
    v_fma_f32 v122, v122, s55, -v232
    v_fma_f32 v123, v123, s55, -v232
    v_fma_f32 v124, v124, s55, -v232
    v_fma_f32 v125, v125, s55, -v232
    v_fma_f32 v126, v126, s55, -v232
    v_fma_f32 v127, v127, s55, -v232
    v_exp_f32 v112, v112
    v_exp_f32 v113, v113
    v_exp_f32 v114, v114
    v_exp_f32 v115, v115
    v_exp_f32 v116, v116
    v_exp_f32 v117, v117
    v_exp_f32 v118, v118
    v_exp_f32 v119, v119
    v_exp_f32 v120, v120
    v_exp_f32 v121, v121
    v_exp_f32 v122, v122
    v_exp_f32 v123, v123
    v_exp_f32 v124, v124
    v_exp_f32 v125, v125
    v_exp_f32 v126, v126
    v_exp_f32 v127, v127
    v_mul_f32 v227, v227, v231
    v_mul_f32 v48, v48, v231
    v_mul_f32 v49, v49, v231
    v_mul_f32 v50, v50, v231
    v_mul_f32 v51, v51, v231
    v_mul_f32 v52, v52, v231
    v_mul_f32 v53, v53, v231
    v_mul_f32 v54, v54, v231
    v_mul_f32 v55, v55, v231
    v_mul_f32 v56, v56, v231
    v_mul_f32 v57, v57, v231
    v_mul_f32 v58, v58, v231
    v_mul_f32 v59, v59, v231
    v_mul_f32 v60, v60, v231
    v_mul_f32 v61, v61, v231
    v_mul_f32 v62, v62, v231
    v_mul_f32 v63, v63, v231
    v_mul_f32 v64, v64, v231
    v_mul_f32 v65, v65, v231
    v_mul_f32 v66, v66, v231
    v_mul_f32 v67, v67, v231
    v_mul_f32 v68, v68, v231
    v_mul_f32 v69, v69, v231
    v_mul_f32 v70, v70, v231
    v_mul_f32 v71, v71, v231
    v_mul_f32 v72, v72, v231
    v_mul_f32 v73, v73, v231
    v_mul_f32 v74, v74, v231
    v_mul_f32 v75, v75, v231
    v_mul_f32 v76, v76, v231
    v_mul_f32 v77, v77, v231
    v_mul_f32 v78, v78, v231
    v_mul_f32 v79, v79, v231
    v_mul_f32 v80, v80, v231
    v_mul_f32 v81, v81, v231
    v_mul_f32 v82, v82, v231
    v_mul_f32 v83, v83, v231
    v_mul_f32 v84, v84, v231
    v_mul_f32 v85, v85, v231
    v_mul_f32 v86, v86, v231
    v_mul_f32 v87, v87, v231
    v_mul_f32 v88, v88, v231
    v_mul_f32 v89, v89, v231
    v_mul_f32 v90, v90, v231
    v_mul_f32 v91, v91, v231
    v_mul_f32 v92, v92, v231
    v_mul_f32 v93, v93, v231
    v_mul_f32 v94, v94, v231
    v_mul_f32 v95, v95, v231
    v_mul_f32 v96, v96, v231
    v_mul_f32 v97, v97, v231
    v_mul_f32 v98, v98, v231
    v_mul_f32 v99, v99, v231
    v_mul_f32 v100, v100, v231
    v_mul_f32 v101, v101, v231
    v_mul_f32 v102, v102, v231
    v_mul_f32 v103, v103, v231
    v_mul_f32 v104, v104, v231
    v_mul_f32 v105, v105, v231
    v_mul_f32 v106, v106, v231
    v_mul_f32 v107, v107, v231
    v_mul_f32 v108, v108, v231
    v_mul_f32 v109, v109, v231
    v_mul_f32 v110, v110, v231
    v_mul_f32 v111, v111, v231
    v_add_f32 v227, v227, v112
    v_add_f32 v227, v227, v113
    v_add_f32 v227, v227, v114
    v_add_f32 v227, v227, v115
    v_add_f32 v227, v227, v116
    v_add_f32 v227, v227, v117
    v_add_f32 v227, v227, v118
    v_add_f32 v227, v227, v119
    v_add_f32 v227, v227, v120
    v_add_f32 v227, v227, v121
    v_add_f32 v227, v227, v122
    v_add_f32 v227, v227, v123
    v_add_f32 v227, v227, v124
    v_add_f32 v227, v227, v125
    v_add_f32 v227, v227, v126
    v_add_f32 v227, v227, v127
    v_cvt_pk_bf16_f32 v192, v112, v113
    v_cvt_pk_bf16_f32 v193, v114, v115
    v_cvt_pk_bf16_f32 v194, v116, v117
    v_cvt_pk_bf16_f32 v195, v118, v119
    v_cvt_pk_bf16_f32 v196, v120, v121
    v_cvt_pk_bf16_f32 v197, v122, v123
    v_cvt_pk_bf16_f32 v198, v124, v125
    v_cvt_pk_bf16_f32 v199, v126, v127
    s_waitcnt vmcnt(16)
    ds_read_b64_tr_b16 v[160:161], v212 offset:24576
    ds_read_b64_tr_b16 v[162:163], v213 offset:26624
    ds_read_b64_tr_b16 v[164:165], v212 offset:28672
    ds_read_b64_tr_b16 v[166:167], v213 offset:30720
    ds_read_b64_tr_b16 v[168:169], v214 offset:24576
    ds_read_b64_tr_b16 v[170:171], v215 offset:26624
    ds_read_b64_tr_b16 v[172:173], v214 offset:28672
    ds_read_b64_tr_b16 v[174:175], v215 offset:30720
    ds_read_b64_tr_b16 v[176:177], v216 offset:24576
    ds_read_b64_tr_b16 v[178:179], v217 offset:26624
    ds_read_b64_tr_b16 v[180:181], v216 offset:28672
    ds_read_b64_tr_b16 v[182:183], v217 offset:30720
    ds_read_b64_tr_b16 v[184:185], v218 offset:24576
    ds_read_b64_tr_b16 v[186:187], v219 offset:26624
    ds_read_b64_tr_b16 v[188:189], v218 offset:28672
    ds_read_b64_tr_b16 v[190:191], v219 offset:30720
    s_waitcnt lgkmcnt(14)
    v_mfma_f32_32x32x16_bf16 v[48:63], v[160:163], v[192:195], v[48:63]
    s_waitcnt lgkmcnt(12)
    v_mfma_f32_32x32x16_bf16 v[48:63], v[164:167], v[196:199], v[48:63]
    s_waitcnt lgkmcnt(10)
    v_mfma_f32_32x32x16_bf16 v[64:79], v[168:171], v[192:195], v[64:79]
    s_waitcnt lgkmcnt(8)
    v_mfma_f32_32x32x16_bf16 v[64:79], v[172:175], v[196:199], v[64:79]
    s_waitcnt lgkmcnt(6)
    v_mfma_f32_32x32x16_bf16 v[80:95], v[176:179], v[192:195], v[80:95]
    s_waitcnt lgkmcnt(4)
    v_mfma_f32_32x32x16_bf16 v[80:95], v[180:183], v[196:199], v[80:95]
    s_waitcnt lgkmcnt(2)
    v_mfma_f32_32x32x16_bf16 v[96:111], v[184:187], v[192:195], v[96:111]
    s_waitcnt lgkmcnt(0)
    v_mfma_f32_32x32x16_bf16 v[96:111], v[188:191], v[196:199], v[96:111]
    s_waitcnt vmcnt(8)
    ds_read_b128 v[128:131], v204 offset:8192
    ds_read_b128 v[132:135], v205 offset:8192
    ds_read_b128 v[136:139], v206 offset:8192
    ds_read_b128 v[140:143], v207 offset:8192
    ds_read_b128 v[144:147], v208 offset:8192
    ds_read_b128 v[148:151], v209 offset:8192
    ds_read_b128 v[152:155], v210 offset:8192
    ds_read_b128 v[156:159], v211 offset:8192
    s_waitcnt lgkmcnt(7)
    v_mfma_f32_32x32x16_bf16 v[112:127], v[128:131], v[16:19], 0
    s_waitcnt lgkmcnt(6)
    v_mfma_f32_32x32x16_bf16 v[112:127], v[132:135], v[20:23], v[112:127]
    s_waitcnt lgkmcnt(5)
    v_mfma_f32_32x32x16_bf16 v[112:127], v[136:139], v[24:27], v[112:127]
    s_waitcnt lgkmcnt(4)
    v_mfma_f32_32x32x16_bf16 v[112:127], v[140:143], v[28:31], v[112:127]
    s_waitcnt lgkmcnt(3)
    v_mfma_f32_32x32x16_bf16 v[112:127], v[144:147], v[32:35], v[112:127]
    s_waitcnt lgkmcnt(2)
    v_mfma_f32_32x32x16_bf16 v[112:127], v[148:151], v[36:39], v[112:127]
    s_waitcnt lgkmcnt(1)
    v_mfma_f32_32x32x16_bf16 v[112:127], v[152:155], v[40:43], v[112:127]
    s_waitcnt lgkmcnt(0)
    v_mfma_f32_32x32x16_bf16 v[112:127], v[156:159], v[44:47], v[112:127]
    s_nop 7
    s_nop 3
    v_max3_f32 v228, v112, v113, v114
    v_max3_f32 v228, v228, v115, v116
    v_max3_f32 v228, v228, v117, v118
    v_max3_f32 v228, v228, v119, v120
    v_max3_f32 v228, v228, v121, v122
    v_max3_f32 v228, v228, v123, v124
    v_max3_f32 v228, v228, v125, v126
    v_max_f32 v228, v228, v127
    v_mov_b32 v229, v228
    s_nop 1
    v_permlane32_swap_b32 v228, v229
    s_nop 1
    v_max3_f32 v228, v228, v229, v226
    v_sub_f32 v231, v226, v228
    v_mul_f32 v231, s55, v231
    v_exp_f32 v231, v231
    v_mul_f32 v232, s55, v228
    v_mov_b32 v226, v228
    v_fma_f32 v112, v112, s55, -v232
    v_fma_f32 v113, v113, s55, -v232
    v_fma_f32 v114, v114, s55, -v232
    v_fma_f32 v115, v115, s55, -v232
    v_fma_f32 v116, v116, s55, -v232
    v_fma_f32 v117, v117, s55, -v232
    v_fma_f32 v118, v118, s55, -v232
    v_fma_f32 v119, v119, s55, -v232
    v_fma_f32 v120, v120, s55, -v232
    v_fma_f32 v121, v121, s55, -v232
    v_fma_f32 v122, v122, s55, -v232
    v_fma_f32 v123, v123, s55, -v232
    v_fma_f32 v124, v124, s55, -v232
    v_fma_f32 v125, v125, s55, -v232
    v_fma_f32 v126, v126, s55, -v232
    v_fma_f32 v127, v127, s55, -v232
    v_exp_f32 v112, v112
    v_exp_f32 v113, v113
    v_exp_f32 v114, v114
    v_exp_f32 v115, v115
    v_exp_f32 v116, v116
    v_exp_f32 v117, v117
    v_exp_f32 v118, v118
    v_exp_f32 v119, v119
    v_exp_f32 v120, v120
    v_exp_f32 v121, v121
    v_exp_f32 v122, v122
    v_exp_f32 v123, v123
    v_exp_f32 v124, v124
    v_exp_f32 v125, v125
    v_exp_f32 v126, v126
    v_exp_f32 v127, v127
    v_mul_f32 v227, v227, v231
    v_mul_f32 v48, v48, v231
    v_mul_f32 v49, v49, v231
    v_mul_f32 v50, v50, v231
    v_mul_f32 v51, v51, v231
    v_mul_f32 v52, v52, v231
    v_mul_f32 v53, v53, v231
    v_mul_f32 v54, v54, v231
    v_mul_f32 v55, v55, v231
    v_mul_f32 v56, v56, v231
    v_mul_f32 v57, v57, v231
    v_mul_f32 v58, v58, v231
    v_mul_f32 v59, v59, v231
    v_mul_f32 v60, v60, v231
    v_mul_f32 v61, v61, v231
    v_mul_f32 v62, v62, v231
    v_mul_f32 v63, v63, v231
    v_mul_f32 v64, v64, v231
    v_mul_f32 v65, v65, v231
    v_mul_f32 v66, v66, v231
    v_mul_f32 v67, v67, v231
    v_mul_f32 v68, v68, v231
    v_mul_f32 v69, v69, v231
    v_mul_f32 v70, v70, v231
    v_mul_f32 v71, v71, v231
    v_mul_f32 v72, v72, v231
    v_mul_f32 v73, v73, v231
    v_mul_f32 v74, v74, v231
    v_mul_f32 v75, v75, v231
    v_mul_f32 v76, v76, v231
    v_mul_f32 v77, v77, v231
    v_mul_f32 v78, v78, v231
    v_mul_f32 v79, v79, v231
    v_mul_f32 v80, v80, v231
    v_mul_f32 v81, v81, v231
    v_mul_f32 v82, v82, v231
    v_mul_f32 v83, v83, v231
    v_mul_f32 v84, v84, v231
    v_mul_f32 v85, v85, v231
    v_mul_f32 v86, v86, v231
    v_mul_f32 v87, v87, v231
    v_mul_f32 v88, v88, v231
    v_mul_f32 v89, v89, v231
    v_mul_f32 v90, v90, v231
    v_mul_f32 v91, v91, v231
    v_mul_f32 v92, v92, v231
    v_mul_f32 v93, v93, v231
    v_mul_f32 v94, v94, v231
    v_mul_f32 v95, v95, v231
    v_mul_f32 v96, v96, v231
    v_mul_f32 v97, v97, v231
    v_mul_f32 v98, v98, v231
    v_mul_f32 v99, v99, v231
    v_mul_f32 v100, v100, v231
    v_mul_f32 v101, v101, v231
    v_mul_f32 v102, v102, v231
    v_mul_f32 v103, v103, v231
    v_mul_f32 v104, v104, v231
    v_mul_f32 v105, v105, v231
    v_mul_f32 v106, v106, v231
    v_mul_f32 v107, v107, v231
    v_mul_f32 v108, v108, v231
    v_mul_f32 v109, v109, v231
    v_mul_f32 v110, v110, v231
    v_mul_f32 v111, v111, v231
    v_add_f32 v227, v227, v112
    v_add_f32 v227, v227, v113
    v_add_f32 v227, v227, v114
    v_add_f32 v227, v227, v115
    v_add_f32 v227, v227, v116
    v_add_f32 v227, v227, v117
    v_add_f32 v227, v227, v118
    v_add_f32 v227, v227, v119
    v_add_f32 v227, v227, v120
    v_add_f32 v227, v227, v121
    v_add_f32 v227, v227, v122
    v_add_f32 v227, v227, v123
    v_add_f32 v227, v227, v124
    v_add_f32 v227, v227, v125
    v_add_f32 v227, v227, v126
    v_add_f32 v227, v227, v127
    v_cvt_pk_bf16_f32 v192, v112, v113
    v_cvt_pk_bf16_f32 v193, v114, v115
    v_cvt_pk_bf16_f32 v194, v116, v117
    v_cvt_pk_bf16_f32 v195, v118, v119
    v_cvt_pk_bf16_f32 v196, v120, v121
    v_cvt_pk_bf16_f32 v197, v122, v123
    v_cvt_pk_bf16_f32 v198, v124, v125
    v_cvt_pk_bf16_f32 v199, v126, v127
    v_mov_b32 v229, v227
    s_nop 1
    v_permlane32_swap_b32 v227, v229
    s_nop 1
    v_add_f32 v229, v227, v229
    v_mov_b32 v228, v226
    s_waitcnt vmcnt(0)
    ds_read_b64_tr_b16 v[160:161], v212 offset:16384
    ds_read_b64_tr_b16 v[162:163], v213 offset:18432
    ds_read_b64_tr_b16 v[164:165], v212 offset:20480
    ds_read_b64_tr_b16 v[166:167], v213 offset:22528
    ds_read_b64_tr_b16 v[168:169], v214 offset:16384
    ds_read_b64_tr_b16 v[170:171], v215 offset:18432
    ds_read_b64_tr_b16 v[172:173], v214 offset:20480
    ds_read_b64_tr_b16 v[174:175], v215 offset:22528
    ds_read_b64_tr_b16 v[176:177], v216 offset:16384
    ds_read_b64_tr_b16 v[178:179], v217 offset:18432
    ds_read_b64_tr_b16 v[180:181], v216 offset:20480
    ds_read_b64_tr_b16 v[182:183], v217 offset:22528
    ds_read_b64_tr_b16 v[184:185], v218 offset:16384
    ds_read_b64_tr_b16 v[186:187], v219 offset:18432
    ds_read_b64_tr_b16 v[188:189], v218 offset:20480
    ds_read_b64_tr_b16 v[190:191], v219 offset:22528
    ds_write_b64 v249, v[228:229] offset:24576
    s_waitcnt lgkmcnt(15)
    v_mfma_f32_32x32x16_bf16 v[48:63], v[160:163], v[192:195], v[48:63]
    s_waitcnt lgkmcnt(13)
    v_mfma_f32_32x32x16_bf16 v[48:63], v[164:167], v[196:199], v[48:63]
    s_waitcnt lgkmcnt(11)
    v_mfma_f32_32x32x16_bf16 v[64:79], v[168:171], v[192:195], v[64:79]
    s_waitcnt lgkmcnt(9)
    v_mfma_f32_32x32x16_bf16 v[64:79], v[172:175], v[196:199], v[64:79]
    s_waitcnt lgkmcnt(0)
    v_mfma_f32_32x32x16_bf16 v[80:95], v[176:179], v[192:195], v[80:95]
    v_mfma_f32_32x32x16_bf16 v[80:95], v[180:183], v[196:199], v[80:95]
    s_nop 4
    ds_write_b128 v246, v[48:51] offset:8192
    ds_write_b128 v246, v[52:55] offset:9216
    ds_write_b128 v246, v[56:59] offset:10240
    ds_write_b128 v246, v[60:63] offset:11264
    v_mfma_f32_32x32x16_bf16 v[96:111], v[184:187], v[192:195], v[96:111]
    v_mfma_f32_32x32x16_bf16 v[96:111], v[188:191], v[196:199], v[96:111]
    ds_write_b128 v246, v[64:67] offset:12288
    ds_write_b128 v246, v[68:71] offset:13312
    ds_write_b128 v246, v[72:75] offset:14336
    ds_write_b128 v246, v[76:79] offset:15360
    s_nop 1
    ds_write_b128 v246, v[80:83] offset:16384
    ds_write_b128 v246, v[84:87] offset:17408
    ds_write_b128 v246, v[88:91] offset:18432
    ds_write_b128 v246, v[92:95] offset:19456
    s_nop 3
    ds_write_b128 v246, v[96:99] offset:20480
    ds_write_b128 v246, v[100:103] offset:21504
    ds_write_b128 v246, v[104:107] offset:22528
    ds_write_b128 v246, v[108:111] offset:23552
    s_waitcnt lgkmcnt(0)
    s_barrier
    ds_read_b64 v[192:193], v250 offset:0
    ds_read_b64 v[194:195], v250 offset:40960
    ds_read_b64 v[196:197], v245 offset:0
    ds_read_b64 v[198:199], v245 offset:40960
    ds_read_b128 v[128:131], v247 offset:8192
    ds_read_b128 v[132:135], v247 offset:9216
    ds_read_b128 v[136:139], v247 offset:10240
    ds_read_b128 v[140:143], v247 offset:11264
    ds_read_b128 v[144:147], v247 offset:49152
    ds_read_b128 v[148:151], v247 offset:50176
    ds_read_b128 v[152:155], v247 offset:51200
    ds_read_b128 v[156:159], v247 offset:52224
    ds_read_b128 v[160:163], v248 offset:8192
    ds_read_b128 v[164:167], v248 offset:9216
    ds_read_b128 v[168:171], v248 offset:10240
    ds_read_b128 v[172:175], v248 offset:11264
    ds_read_b128 v[176:179], v248 offset:49152
    ds_read_b128 v[180:183], v248 offset:50176
    ds_read_b128 v[184:187], v248 offset:51200
    ds_read_b128 v[188:191], v248 offset:52224
    s_waitcnt lgkmcnt(15)
    v_max3_f32 v228, v192, v194, v196
    v_max_f32 v228, v228, v198
    v_sub_f32 v200, v192, v228
    v_mul_f32 v200, s55, v200
    v_exp_f32 v200, v200
    v_sub_f32 v201, v194, v228
    v_mul_f32 v201, s55, v201
    v_exp_f32 v201, v201
    v_sub_f32 v202, v196, v228
    v_mul_f32 v202, s55, v202
    v_exp_f32 v202, v202
    v_sub_f32 v203, v198, v228
    v_mul_f32 v203, s55, v203
    v_exp_f32 v203, v203
    s_nop 0
    v_mul_f32 v229, v200, v193
    v_fmac_f32 v229, v201, v195
    v_fmac_f32 v229, v202, v197
    v_fmac_f32 v229, v203, v199
    v_rcp_f32 v229, v229
    s_nop 0
    v_mul_f32 v200, v200, v229
    v_mul_f32 v201, v201, v229
    v_mul_f32 v202, v202, v229
    v_mul_f32 v203, v203, v229
    s_waitcnt lgkmcnt(12)
    v_mul_f32 v112, v200, v128
    v_mul_f32 v113, v200, v129
    v_mul_f32 v114, v200, v130
    v_mul_f32 v115, v200, v131
    v_mul_f32 v116, v200, v132
    v_mul_f32 v117, v200, v133
    v_mul_f32 v118, v200, v134
    v_mul_f32 v119, v200, v135
    v_mul_f32 v120, v200, v136
    v_mul_f32 v121, v200, v137
    v_mul_f32 v122, v200, v138
    v_mul_f32 v123, v200, v139
    v_mul_f32 v124, v200, v140
    v_mul_f32 v125, v200, v141
    v_mul_f32 v126, v200, v142
    v_mul_f32 v127, v200, v143
    s_waitcnt lgkmcnt(8)
    v_fmac_f32 v112, v201, v144
    v_fmac_f32 v113, v201, v145
    v_fmac_f32 v114, v201, v146
    v_fmac_f32 v115, v201, v147
    v_fmac_f32 v116, v201, v148
    v_fmac_f32 v117, v201, v149
    v_fmac_f32 v118, v201, v150
    v_fmac_f32 v119, v201, v151
    v_fmac_f32 v120, v201, v152
    v_fmac_f32 v121, v201, v153
    v_fmac_f32 v122, v201, v154
    v_fmac_f32 v123, v201, v155
    v_fmac_f32 v124, v201, v156
    v_fmac_f32 v125, v201, v157
    v_fmac_f32 v126, v201, v158
    v_fmac_f32 v127, v201, v159
    s_waitcnt lgkmcnt(4)
    v_fmac_f32 v112, v202, v160
    v_fmac_f32 v113, v202, v161
    v_fmac_f32 v114, v202, v162
    v_fmac_f32 v115, v202, v163
    v_fmac_f32 v116, v202, v164
    v_fmac_f32 v117, v202, v165
    v_fmac_f32 v118, v202, v166
    v_fmac_f32 v119, v202, v167
    v_fmac_f32 v120, v202, v168
    v_fmac_f32 v121, v202, v169
    v_fmac_f32 v122, v202, v170
    v_fmac_f32 v123, v202, v171
    v_fmac_f32 v124, v202, v172
    v_fmac_f32 v125, v202, v173
    v_fmac_f32 v126, v202, v174
    v_fmac_f32 v127, v202, v175
    s_waitcnt lgkmcnt(0)
    v_fmac_f32 v112, v203, v176
    v_fmac_f32 v113, v203, v177
    v_fmac_f32 v114, v203, v178
    v_fmac_f32 v115, v203, v179
    v_fmac_f32 v116, v203, v180
    v_fmac_f32 v117, v203, v181
    v_fmac_f32 v118, v203, v182
    v_fmac_f32 v119, v203, v183
    v_fmac_f32 v120, v203, v184
    v_fmac_f32 v121, v203, v185
    v_fmac_f32 v122, v203, v186
    v_fmac_f32 v123, v203, v187
    v_fmac_f32 v124, v203, v188
    v_fmac_f32 v125, v203, v189
    v_fmac_f32 v126, v203, v190
    v_fmac_f32 v127, v203, v191
    v_cvt_pk_bf16_f32 v192, v112, v113
    v_cvt_pk_bf16_f32 v193, v114, v115
    v_cvt_pk_bf16_f32 v194, v116, v117
    v_cvt_pk_bf16_f32 v195, v118, v119
    v_cvt_pk_bf16_f32 v196, v120, v121
    v_cvt_pk_bf16_f32 v197, v122, v123
    v_cvt_pk_bf16_f32 v198, v124, v125
    v_cvt_pk_bf16_f32 v199, v126, v127
    s_nop 1
    v_permlane32_swap_b32 v192, v194
    v_permlane32_swap_b32 v193, v195
    v_permlane32_swap_b32 v196, v198
    v_permlane32_swap_b32 v197, v199
    buffer_store_dwordx4 v[192:195], v244, s[40:43], s82 offen sc1
    buffer_store_dwordx4 v[196:199], v244, s[40:43], s82 offen offset:512 sc1
    s_waitcnt vmcnt(0)
    s_barrier
    s_cmp_lg_u32 s3, 0
    s_cbranch_scc1 L_noflag_51
    s_mov_b64 exec, 1
    buffer_store_dword v252, v251, s[40:43], 0 offen sc1
    s_mov_b64 exec, -1
L_noflag_51:
    s_mov_b32 s58, 400000
    buffer_load_dword v220, v221, s[40:43], 0 offen sc1
L_opoll_52:
    buffer_load_dword v222, v221, s[40:43], 0 offen sc1
    s_waitcnt vmcnt(1)
    v_cmp_ne_u32 vcc, s56, v220
    s_cbranch_vccz L_ogot_53
    buffer_load_dword v220, v221, s[40:43], 0 offen sc1
    s_sub_u32 s58, s58, 1
    s_cmp_eq_u32 s58, 0
    s_cbranch_scc1 L_end
    s_waitcnt vmcnt(1)
    v_cmp_ne_u32 vcc, s56, v222
    s_cbranch_vccnz L_opoll_52
L_ogot_53:
    s_mov_b32 s52, s83
    buffer_load_dwordx4 v[64:67], v240, s[40:43], s52 offen offset:0 sc1
    buffer_load_dwordx4 v[68:71], v240, s[40:43], s52 offen offset:1024 sc1
    buffer_load_dwordx4 v[72:75], v240, s[40:43], s52 offen offset:2048 sc1
    buffer_load_dwordx4 v[76:79], v240, s[40:43], s52 offen offset:3072 sc1
    s_add_u32 s52, s52, 4096
    buffer_load_dwordx4 v[80:83], v240, s[40:43], s52 offen offset:0 sc1
    buffer_load_dwordx4 v[84:87], v240, s[40:43], s52 offen offset:1024 sc1
    buffer_load_dwordx4 v[88:91], v240, s[40:43], s52 offen offset:2048 sc1
    buffer_load_dwordx4 v[92:95], v240, s[40:43], s52 offen offset:3072 sc1
    s_add_u32 s52, s52, 4096
    buffer_load_dwordx4 v[96:99], v240, s[40:43], s52 offen offset:0 sc1
    buffer_load_dwordx4 v[100:103], v240, s[40:43], s52 offen offset:1024 sc1
    buffer_load_dwordx4 v[104:107], v240, s[40:43], s52 offen offset:2048 sc1
    buffer_load_dwordx4 v[108:111], v240, s[40:43], s52 offen offset:3072 sc1
    s_add_u32 s52, s52, 4096
    buffer_load_dwordx4 v[112:115], v240, s[40:43], s52 offen offset:0 sc1
    buffer_load_dwordx4 v[116:119], v240, s[40:43], s52 offen offset:1024 sc1
    buffer_load_dwordx4 v[120:123], v240, s[40:43], s52 offen offset:2048 sc1
    buffer_load_dwordx4 v[124:127], v240, s[40:43], s52 offen offset:3072 sc1
    s_add_u32 s52, s52, 4096
    buffer_load_dwordx4 v[128:131], v240, s[40:43], s52 offen offset:0 sc1
    buffer_load_dwordx4 v[132:135], v240, s[40:43], s52 offen offset:1024 sc1
    buffer_load_dwordx4 v[136:139], v240, s[40:43], s52 offen offset:2048 sc1
    buffer_load_dwordx4 v[140:143], v240, s[40:43], s52 offen offset:3072 sc1
    s_add_u32 s52, s52, 4096
    buffer_load_dwordx4 v[144:147], v240, s[40:43], s52 offen offset:0 sc1
    buffer_load_dwordx4 v[148:151], v240, s[40:43], s52 offen offset:1024 sc1
    buffer_load_dwordx4 v[152:155], v240, s[40:43], s52 offen offset:2048 sc1
    buffer_load_dwordx4 v[156:159], v240, s[40:43], s52 offen offset:3072 sc1
    s_add_u32 s52, s52, 4096
    buffer_load_dwordx4 v[160:163], v240, s[40:43], s52 offen offset:0 sc1
    buffer_load_dwordx4 v[164:167], v240, s[40:43], s52 offen offset:1024 sc1
    buffer_load_dwordx4 v[168:171], v240, s[40:43], s52 offen offset:2048 sc1
    buffer_load_dwordx4 v[172:175], v240, s[40:43], s52 offen offset:3072 sc1
    s_add_u32 s52, s52, 4096
    buffer_load_dwordx4 v[176:179], v240, s[40:43], s52 offen offset:0 sc1
    buffer_load_dwordx4 v[180:183], v240, s[40:43], s52 offen offset:1024 sc1
    buffer_load_dwordx4 v[184:187], v240, s[40:43], s52 offen offset:2048 sc1
    buffer_load_dwordx4 v[188:191], v240, s[40:43], s52 offen offset:3072 sc1
    s_mov_b32 s44, s14
    s_mov_b32 s45, s15
    s_mov_b32 s46, 262144
    s_mov_b32 s47, 0x20000
    v_add_u32 v11, s48, v240
    v_lshrrev_b32 v2, 4, v0
    v_and_b32 v3, 15, v0
    v_lshrrev_b32 v4, 1, v2
    v_lshlrev_b32 v4, 10, v4
    v_and_b32 v5, 1, v2
    v_lshlrev_b32 v5, 9, v5
    v_add_u32 v4, v4, v5
    v_lshlrev_b32 v5, 4, v3
    v_add_u32 v12, v4, v5
    v_add_u32 v13, 81920, v12
    s_lshl_b32 s53, s61, 4
    v_add_u32 v14, s53, v3
    v_lshlrev_b32 v14, 10, v14
    v_lshlrev_b32 v5, 4, v2
    v_add_u32 v14, v14, v5
    s_lshl_b32 s53, s62, 6
    s_waitcnt vmcnt(30)
    v_mfma_f32_16x16x32_bf16 v[16:19], a[0:3], v[64:67], 0
    v_mfma_f32_16x16x32_bf16 v[20:23], a[4:7], v[64:67], 0
    v_mfma_f32_16x16x32_bf16 v[16:19], a[8:11], v[68:71], v[16:19]
    v_mfma_f32_16x16x32_bf16 v[20:23], a[12:15], v[68:71], v[20:23]
    s_waitcnt vmcnt(28)
    v_mfma_f32_16x16x32_bf16 v[16:19], a[16:19], v[72:75], v[16:19]
    v_mfma_f32_16x16x32_bf16 v[20:23], a[20:23], v[72:75], v[20:23]
    v_mfma_f32_16x16x32_bf16 v[16:19], a[24:27], v[76:79], v[16:19]
    v_mfma_f32_16x16x32_bf16 v[20:23], a[28:31], v[76:79], v[20:23]
    s_waitcnt vmcnt(26)
    v_mfma_f32_16x16x32_bf16 v[16:19], a[32:35], v[80:83], v[16:19]
    v_mfma_f32_16x16x32_bf16 v[20:23], a[36:39], v[80:83], v[20:23]
    v_mfma_f32_16x16x32_bf16 v[16:19], a[40:43], v[84:87], v[16:19]
    v_mfma_f32_16x16x32_bf16 v[20:23], a[44:47], v[84:87], v[20:23]
    s_waitcnt vmcnt(24)
    v_mfma_f32_16x16x32_bf16 v[16:19], a[48:51], v[88:91], v[16:19]
    v_mfma_f32_16x16x32_bf16 v[20:23], a[52:55], v[88:91], v[20:23]
    v_mfma_f32_16x16x32_bf16 v[16:19], a[56:59], v[92:95], v[16:19]
    v_mfma_f32_16x16x32_bf16 v[20:23], a[60:63], v[92:95], v[20:23]
    s_waitcnt vmcnt(22)
    v_mfma_f32_16x16x32_bf16 v[16:19], a[64:67], v[96:99], v[16:19]
    v_mfma_f32_16x16x32_bf16 v[20:23], a[68:71], v[96:99], v[20:23]
    v_mfma_f32_16x16x32_bf16 v[16:19], a[72:75], v[100:103], v[16:19]
    v_mfma_f32_16x16x32_bf16 v[20:23], a[76:79], v[100:103], v[20:23]
    s_waitcnt vmcnt(20)
    v_mfma_f32_16x16x32_bf16 v[16:19], a[80:83], v[104:107], v[16:19]
    v_mfma_f32_16x16x32_bf16 v[20:23], a[84:87], v[104:107], v[20:23]
    v_mfma_f32_16x16x32_bf16 v[16:19], a[88:91], v[108:111], v[16:19]
    v_mfma_f32_16x16x32_bf16 v[20:23], a[92:95], v[108:111], v[20:23]
    s_waitcnt vmcnt(18)
    v_mfma_f32_16x16x32_bf16 v[16:19], a[96:99], v[112:115], v[16:19]
    v_mfma_f32_16x16x32_bf16 v[20:23], a[100:103], v[112:115], v[20:23]
    v_mfma_f32_16x16x32_bf16 v[16:19], a[104:107], v[116:119], v[16:19]
    v_mfma_f32_16x16x32_bf16 v[20:23], a[108:111], v[116:119], v[20:23]
    s_waitcnt vmcnt(16)
    v_mfma_f32_16x16x32_bf16 v[16:19], a[112:115], v[120:123], v[16:19]
    v_mfma_f32_16x16x32_bf16 v[20:23], a[116:119], v[120:123], v[20:23]
    v_mfma_f32_16x16x32_bf16 v[16:19], a[120:123], v[124:127], v[16:19]
    v_mfma_f32_16x16x32_bf16 v[20:23], a[124:127], v[124:127], v[20:23]
    s_waitcnt vmcnt(14)
    v_mfma_f32_16x16x32_bf16 v[16:19], a[128:131], v[128:131], v[16:19]
    v_mfma_f32_16x16x32_bf16 v[20:23], a[132:135], v[128:131], v[20:23]
    v_mfma_f32_16x16x32_bf16 v[16:19], a[136:139], v[132:135], v[16:19]
    v_mfma_f32_16x16x32_bf16 v[20:23], a[140:143], v[132:135], v[20:23]
    s_waitcnt vmcnt(12)
    v_mfma_f32_16x16x32_bf16 v[16:19], a[144:147], v[136:139], v[16:19]
    v_mfma_f32_16x16x32_bf16 v[20:23], a[148:151], v[136:139], v[20:23]
    v_mfma_f32_16x16x32_bf16 v[16:19], a[152:155], v[140:143], v[16:19]
    v_mfma_f32_16x16x32_bf16 v[20:23], a[156:159], v[140:143], v[20:23]
    s_waitcnt vmcnt(10)
    v_mfma_f32_16x16x32_bf16 v[16:19], a[160:163], v[144:147], v[16:19]
    v_mfma_f32_16x16x32_bf16 v[20:23], a[164:167], v[144:147], v[20:23]
    v_mfma_f32_16x16x32_bf16 v[16:19], a[168:171], v[148:151], v[16:19]
    v_mfma_f32_16x16x32_bf16 v[20:23], a[172:175], v[148:151], v[20:23]
    s_waitcnt vmcnt(8)
    v_mfma_f32_16x16x32_bf16 v[16:19], a[176:179], v[152:155], v[16:19]
    v_mfma_f32_16x16x32_bf16 v[20:23], a[180:183], v[152:155], v[20:23]
    v_mfma_f32_16x16x32_bf16 v[16:19], a[184:187], v[156:159], v[16:19]
    v_mfma_f32_16x16x32_bf16 v[20:23], a[188:191], v[156:159], v[20:23]
    s_waitcnt vmcnt(6)
    v_mfma_f32_16x16x32_bf16 v[16:19], a[192:195], v[160:163], v[16:19]
    v_mfma_f32_16x16x32_bf16 v[20:23], a[196:199], v[160:163], v[20:23]
    v_mfma_f32_16x16x32_bf16 v[16:19], a[200:203], v[164:167], v[16:19]
    v_mfma_f32_16x16x32_bf16 v[20:23], a[204:207], v[164:167], v[20:23]
    s_waitcnt vmcnt(4)
    v_mfma_f32_16x16x32_bf16 v[16:19], a[208:211], v[168:171], v[16:19]
    v_mfma_f32_16x16x32_bf16 v[20:23], a[212:215], v[168:171], v[20:23]
    v_mfma_f32_16x16x32_bf16 v[16:19], a[216:219], v[172:175], v[16:19]
    v_mfma_f32_16x16x32_bf16 v[20:23], a[220:223], v[172:175], v[20:23]
    s_waitcnt vmcnt(2)
    v_mfma_f32_16x16x32_bf16 v[16:19], a[224:227], v[176:179], v[16:19]
    v_mfma_f32_16x16x32_bf16 v[20:23], a[228:231], v[176:179], v[20:23]
    v_mfma_f32_16x16x32_bf16 v[16:19], a[232:235], v[180:183], v[16:19]
    v_mfma_f32_16x16x32_bf16 v[20:23], a[236:239], v[180:183], v[20:23]
    s_waitcnt vmcnt(0)
    v_mfma_f32_16x16x32_bf16 v[16:19], a[240:243], v[184:187], v[16:19]
    v_mfma_f32_16x16x32_bf16 v[20:23], a[244:247], v[184:187], v[20:23]
    v_mfma_f32_16x16x32_bf16 v[16:19], a[248:251], v[188:191], v[16:19]
    v_mfma_f32_16x16x32_bf16 v[20:23], a[252:255], v[188:191], v[20:23]
    s_nop 7
    ds_write_b128 v11, v[16:19] offset:8192
    ds_write_b128 v11, v[20:23] offset:9216
    s_waitcnt lgkmcnt(0)
    s_barrier
    s_cmp_lg_u32 s3, 0
    s_cbranch_scc1 L_fin
    ds_read_b128 v[24:27], v12 offset:8192
    ds_read_b128 v[28:31], v12 offset:8448
    ds_read_b128 v[32:35], v12 offset:49152
    ds_read_b128 v[36:39], v12 offset:49408
    ds_read_b128 v[40:43], v13 offset:8192
    ds_read_b128 v[44:47], v13 offset:8448
    ds_read_b128 v[48:51], v13 offset:49152
    ds_read_b128 v[52:55], v13 offset:49408
    s_waitcnt lgkmcnt(4)
    v_add_f32 v24, v24, v32
    v_add_f32 v25, v25, v33
    v_add_f32 v26, v26, v34
    v_add_f32 v27, v27, v35
    v_add_f32 v28, v28, v36
    v_add_f32 v29, v29, v37
    v_add_f32 v30, v30, v38
    v_add_f32 v31, v31, v39
    s_waitcnt lgkmcnt(0)
    v_add_f32 v40, v40, v48
    v_add_f32 v41, v41, v49
    v_add_f32 v42, v42, v50
    v_add_f32 v43, v43, v51
    v_add_f32 v44, v44, v52
    v_add_f32 v45, v45, v53
    v_add_f32 v46, v46, v54
    v_add_f32 v47, v47, v55
    v_add_f32 v24, v24, v40
    v_add_f32 v25, v25, v41
    v_add_f32 v26, v26, v42
    v_add_f32 v27, v27, v43
    v_add_f32 v28, v28, v44
    v_add_f32 v29, v29, v45
    v_add_f32 v30, v30, v46
    v_add_f32 v31, v31, v47
    v_cvt_pk_bf16_f32 v24, v24, v25
    v_cvt_pk_bf16_f32 v25, v26, v27
    v_cvt_pk_bf16_f32 v26, v28, v29
    v_cvt_pk_bf16_f32 v27, v30, v31
    buffer_store_dwordx4 v[24:27], v14, s[44:47], s53 offen
L_fin:
L_end:
    s_endpgm
.section .rodata,"a"
.p2align 6
.amdhsa_kernel standalone__gqa_block_cached__sampling_kernel
  .amdhsa_next_free_vgpr 512
  .amdhsa_next_free_sgpr 100
  .amdhsa_accum_offset 256
  .amdhsa_group_segment_fixed_size 0
  .amdhsa_kernarg_size 64
  .amdhsa_user_sgpr_count 2
  .amdhsa_user_sgpr_kernarg_segment_ptr 1
  .amdhsa_system_sgpr_workgroup_id_x 1
  .amdhsa_float_denorm_mode_32 3
.end_amdhsa_kernel
```
